```python
import torch

def _softmax(x, axis=-1):
    return torch.softmax(x, dim=axis)
def _gelu(x):
    return torch.nn.functional.gelu(x, approximate="tanh")
def _silu(x):
    return torch.nn.functional.silu(x)
def _sigmoid(x):
    return torch.sigmoid(x)
def _layernorm(x, axis=-1, eps=1e-5):
    m = x.mean(dim=axis, keepdim=True)
    v = x.var(dim=axis, keepdim=True, unbiased=False)
    return (x - m) / torch.sqrt(v + eps)
def _scatter_add(tgt, idx, src, axis=0):
    return tgt.clone().index_add_(axis, idx, src)
def _segment_sum(src, seg, n):
    out = torch.zeros((n,) + src.shape[1:], dtype=src.dtype)
    return out.index_add_(0, seg, src)
def _pad(x, pw):
    flat = tuple(v for pair in reversed(pw) for v in pair)
    return torch.nn.functional.pad(x, flat)

kernel_name = 'parallel_sum__ssm_conv_s4__glu_gated_reglu__prompt'

def setup_inputs():

    _w = (lambda a: (lambda t: t.to(torch.bfloat16) if t.is_floating_point() else t)(torch.as_tensor(a)))
    def _A_setup():
        B, L, D, N = 1, 2048, 512, 128
        A_re = -(lambda _x: torch.exp(torch.as_tensor(_x)))((lambda *s: torch.randn(*s, dtype=torch.bfloat16) * 6.4)(D, N))
        A_im = torch.pi * (lambda *s: torch.randn(*s, dtype=torch.bfloat16) * 0.05)(D, N)
        B_re = (lambda *s: torch.randn(*s, dtype=torch.bfloat16) * 0.1)(D, N)
        B_im = (lambda *s: torch.randn(*s, dtype=torch.bfloat16) * 0.1)(D, N)
        C_re = (lambda *s: torch.randn(*s, dtype=torch.bfloat16) * 0.1)(D, N)
        C_im = (lambda *s: torch.randn(*s, dtype=torch.bfloat16) * 0.1)(D, N)
        log_dt = (lambda *s: torch.randn(*s, dtype=torch.bfloat16) * 0.05)(D) * 0.5 - 4.0
        Dskip = (lambda *s: torch.randn(*s, dtype=torch.bfloat16) * 0.05)(D)
        return {
            "u": _w((lambda *s: torch.randn(*s, dtype=torch.bfloat16) * 0.05)(B, L, D)),
            "A_re": _w(A_re),
            "A_im": _w(A_im),
            "B_re": _w(B_re),
            "B_im": _w(B_im),
            "C_re": _w(C_re),
            "C_im": _w(C_im),
            "log_dt": _w(log_dt),
            "Dskip": _w(Dskip),
        }
    _A_in = _A_setup()

    def _B_setup():
        B, S, D, F = 1, 2048, 512, 1792
        return {
            "x": _w((lambda *s: torch.randn(*s, dtype=torch.bfloat16) * 0.05)(B, S, D)),
            "W_gate": _w((lambda *s: torch.randn(*s, dtype=torch.bfloat16) * 0.4)(D, F) * (2.0 / D) ** 0.5),
            "W_up": _w((lambda *s: torch.randn(*s, dtype=torch.bfloat16) * 0.4)(D, F) * (2.0 / D) ** 0.5),
            "W_down": _w((lambda *s: torch.randn(*s, dtype=torch.bfloat16) * 0.4)(F, D) * (1.0 / F) ** 0.5),
        }
    _B_in = _B_setup()

    return {
        "A_u": _A_in["u"],
        "A_A_re": _A_in["A_re"],
        "A_A_im": _A_in["A_im"],
        "A_B_re": _A_in["B_re"],
        "A_B_im": _A_in["B_im"],
        "A_C_re": _A_in["C_re"],
        "A_C_im": _A_in["C_im"],
        "A_log_dt": _A_in["log_dt"],
        "A_Dskip": _A_in["Dskip"],
        "B_x": _B_in["x"],
        "B_W_gate": _B_in["W_gate"],
        "B_W_up": _B_in["W_up"],
        "B_W_down": _B_in["W_down"],
    }

def reference(A_u, A_A_re, A_A_im, A_B_re, A_B_im, A_C_re, A_C_im, A_log_dt, A_Dskip, B_x, B_W_gate, B_W_up, B_W_down):
    def _A_ref(u, A_re, A_im, B_re, B_im, C_re, C_im, log_dt, Dskip):
        Bsz, L, D = u.shape
        dt = torch.exp(log_dt)[:, None]
        A = A_re + 1j * A_im
        Bc = B_re + 1j * B_im
        Cc = C_re + 1j * C_im
        logdA = dt * A
        dB = dt * Bc
        l = (lambda x, dt: x.to(dt))(torch.arange(L), A_re.dtype)
        P = torch.exp(logdA[:, :, None] * l[None, None, :])
        K = torch.einsum("dn,dnl,dn->dl", Cc, P, dB).real
        L2 = 2 * L
        Kp = _pad(K, ((0, 0), (0, L)))
        up = (lambda x, *d: x.permute(*d))(u, 0, 2, 1)
        up = _pad(up, ((0, 0), (0, 0), (0, L)))
        Kf = (lambda x, axes=(-2,-1): torch.fft.rfft2(x.float(), dim=axes))(Kp[:, None, :], axes=(-2, -1))
        Uf = (lambda x, axes=(-2,-1): torch.fft.rfft2(x.float(), dim=axes))(up[:, :, None, :], axes=(-2, -1))
        Yf = Uf * Kf[None, :, :, :]
        y = (lambda x, s, axes=(-2,-1): torch.fft.irfft2(x, s=s, dim=axes).to(torch.bfloat16))(Yf, (1, L2), axes=(-2, -1))[:, :, 0, :L]
        y = (lambda x, *d: x.permute(*d))(y, 0, 2, 1) + u * Dskip[None, None, :]
        return y

    def _B_ref(x, W_gate, W_up, W_down):
        gate = torch.einsum("bsd,df->bsf", x, W_gate)
        up = torch.einsum("bsd,df->bsf", x, W_up)
        gate = gate * (lambda x, dt: x.to(dt))(gate > 0, gate.dtype)
        h = gate * up
        return torch.einsum("bsf,fd->bsd", h, W_down)

    x = A_u
    xn = _layernorm(x, axis=-1)
    return x + _A_ref(xn, A_A_re, A_A_im, A_B_re, A_B_im, A_C_re, A_C_im, A_log_dt, A_Dskip) + _B_ref(xn, B_W_gate, B_W_up, B_W_down)
```

```asm
; @launch grid=(256,1,1) block=(512,1,1) lds=163840
.amdgcn_target "amdgcn-amd-amdhsa--gfx950"
.text
.globl parallel_sum__ssm_conv_s4__glu_gated_reglu__prompt_kernel
.p2align 8
.type parallel_sum__ssm_conv_s4__glu_gated_reglu__prompt_kernel,@function
parallel_sum__ssm_conv_s4__glu_gated_reglu__prompt_kernel:
    s_cmp_ge_u32 s2, 256
    s_cbranch_scc1 L_exit
    s_load_dwordx16 s[4:19], s[0:1], 0
    s_load_dwordx16 s[20:35], s[0:1], 64
    v_lshrrev_b32 v1, 6, v0
    s_lshr_b32 s62, s2, 3
    s_getpc_b64 s[64:65]
L_pc:
    v_lshl_add_u32 v24, s62, 3, v1
    v_and_b32 v25, 1, v0
    v_lshl_add_u32 v24, v25, 8, v24
    v_lshlrev_b32 v24, 7, v24
    v_min_u32 v24, L_end-L_pc-4, v24
    s_mov_b64 exec, 3
    global_load_dword v210, v24, s[64:65]
    s_mov_b64 exec, -1
    v_and_b32 v0, 63, v0
    v_readfirstlane_b32 s60, v1
    s_and_b32 s61, s2, 7
    s_mov_b32 s38, 2097152
    s_mov_b32 s39, 0x20000
    s_mov_b32 s42, 1835008
    s_mov_b32 s43, 0x20000
    s_and_b32 s86, s60, 1
    v_lshlrev_b32 v30, 4, v0
    s_cmp_lt_u32 s62, 4
    s_cbranch_scc1 L_role_s
    s_sub_u32 s64, s62, 4
    s_and_b32 s65, s64, 3
    s_lshr_b32 s70, s61, 1
    s_lshl_b32 s70, s70, 2
    s_add_u32 s70, s70, s65
    s_lshr_b32 s64, s64, 2
    s_and_b32 s65, s61, 1
    s_mul_i32 s65, s65, 7
    s_add_u32 s71, s64, s65
    v_lshrrev_b32 v11, 3, v0
    v_lshrrev_b32 v12, 4, v0
    v_and_b32 v13, 7, v0
    v_xor_b32 v13, v13, v12
    v_lshlrev_b32 v13, 4, v13
    v_lshl_add_u32 v9, v11, 12, v13
    s_lshl_b32 s74, s60, 11
    s_lshr_b32 s69, s60, 2
    s_lshl_b32 s65, s70, 17
    s_lshl_b32 s64, s69, 16
    s_add_u32 s65, s65, s64
    s_and_b32 s64, s60, 3
    s_lshl_b32 s64, s64, 10
    s_add_u32 s64, s65, s64
    v_add_u32 v9, s64, v9
    v_xor_b32 v10, 64, v9
    v_add_u32 v10, 31744, v10
    s_lshr_b32 s64, s70, 1
    s_lshl_b32 s73, s64, 7
    s_mul_i32 s72, s64, 229376
    v_lshl_add_u32 v13, v12, 1, s86
    v_bfe_u32 v14, v0, 1, 3
    v_xor_b32 v13, v13, v14
    v_lshlrev_b32 v13, 5, v13
    v_and_b32 v14, 1, v0
    v_lshl_or_b32 v13, v14, 4, v13
    v_mul_u32_u24 v7, 3584, v12
    s_and_b32 s64, s60, 3
    s_mul_i32 s64, s64, 28672
    s_lshl_b32 s65, s71, 8
    s_add_u32 s64, s64, s65
    v_add3_u32 v7, v7, v13, s64
    v_add_u32 v8, 13312, v7
    s_mov_b32 s68, 123904
    s_cmp_lg_u32 s69, 0
    s_waitcnt lgkmcnt(0)
    s_cselect_b32 s40, s26, s24
    s_cselect_b32 s41, s27, s25
    s_mov_b32 s36, s4
    s_mov_b32 s37, s5
    s_add_u32 m0, s74, 65536
    s_nop 0
    buffer_load_dwordx4 v9, s[36:39], s73 offen lds
    buffer_load_dwordx4 v10, s[36:39], s73 offen offset:1024 lds
    s_add_u32 s73, s73, 128
    s_and_b32 s73, s73, 0x3ff
    s_add_u32 m0, s74, 0
    s_nop 0
    buffer_load_dwordx4 v7, s[40:43], s72 offen lds
    buffer_load_dwordx4 v8, s[40:43], s72 offen offset:1024 lds
    s_add_u32 s72, s72, 114688
    s_cmp_eq_u32 s72, 1835008
    s_cmov_b32 s72, 0
    s_lshl_b32 s58, s61, 5
    s_add_u32 s58, s58, s62
    s_lshl_b32 s66, s58, 2
    s_load_dword s63, s[34:35], 0
    s_load_dword s56, s[18:19], s66
    s_load_dword s57, s[20:21], s66
    s_lshl_b32 s65, s58, 1
    s_add_u32 s87, s86, s65
    s_bfe_u32 s77, s60, 0x10001
    s_lshr_b32 s93, s60, 2
    s_lshl_b32 s66, s87, 8
    s_lshl_b32 s65, s77, 7
    s_add_u32 s81, s66, s65
    v_lshl_add_u32 v218, v0, 1, s81
    s_and_b32 s64, s62, 3
    s_lshl_b32 s75, s61, 2
    s_add_u32 s75, s75, s64
    s_lshl_b32 s64, s64, 1
    s_lshr_b32 s65, s62, 2
    s_add_u32 s64, s64, s65
    s_and_b32 s76, s64, 7
    s_mov_b32 s88, 0xffff0000
    s_mov_b32 s46, 1835008
    s_mov_b32 s47, 0x20000
    s_mov_b32 s50, 2097152
    s_mov_b32 s51, 0x20000
    s_mov_b32 s54, 20971520
    s_mov_b32 s55, 0x20000
    s_mov_b32 s44, s28
    s_mov_b32 s45, s29
    s_mov_b32 s48, s30
    s_mov_b32 s49, s31
    s_mov_b32 s52, s34
    s_mov_b32 s53, s35
    v_bfe_u32 v11, v0, 2, 2
    v_lshrrev_b32 v12, 4, v0
    v_lshl_add_u32 v14, v12, 3, v11
    v_lshlrev_b32 v14, 8, v14
    v_and_b32 v24, 3, v0
    v_lshl_or_b32 v14, v24, 3, v14
    v_and_b32 v24, 1, v12
    v_lshl_add_u32 v11, v11, 1, v24
    s_and_b32 s65, s60, 6
    v_xor_b32 v11, s65, v11
    v_lshl_or_b32 v1, v11, 5, v14
    v_xor_b32 v2, 32, v1
    v_and_b32 v11, 15, v0
    v_bfe_u32 v14, v0, 1, 3
    v_xor_b32 v14, v14, v12
    v_lshlrev_b32 v14, 4, v14
    v_lshl_or_b32 v3, v11, 7, v14
    s_lshl_b32 s64, s86, 13
    s_add_u32 s64, s64, 65536
    v_add_u32 v3, s64, v3
    v_xor_b32 v4, 64, v3
    v_bfe_u32 v24, v0, 3, 2
    v_mul_u32_u24 v24, 4160, v24
    v_lshrrev_b32 v25, 5, v0
    v_mul_u32_u24 v25, 16704, v25
    v_and_b32 v26, 7, v0
    v_lshl_add_u32 v24, v26, 2, v24
    v_add3_u32 v24, v24, v25, s68
    v_mov_b32 v25, 0
    ds_write_b32 v24, v25
    v_and_b32 v13, 31, v0
    v_lshlrev_b32 v13, 2, v13
    s_and_b32 s64, s70, 1
    s_lshl_b32 s64, s64, 1
    s_add_u32 s59, s64, s86
    v_mov_b32 v24, 0x3f803f80
    v_cmp_eq_u32 vcc, 0, v11
    s_nop 1
    v_cndmask_b32 v148, 0, v24, vcc
    v_cndmask_b32 v149, 0, v24, vcc
    v_cndmask_b32 v150, 0, v24, vcc
    v_cndmask_b32 v151, 0, v24, vcc
    v_cmp_eq_u32 vcc, 1, v11
    s_nop 1
    v_cndmask_b32 v152, 0, v24, vcc
    v_cndmask_b32 v153, 0, v24, vcc
    v_cndmask_b32 v154, 0, v24, vcc
    v_cndmask_b32 v155, 0, v24, vcc
    v_lshrrev_b32 v24, 2, v0
    v_bfe_u32 v26, v0, 3, 2
    v_lshlrev_b32 v24, 7, v24
    s_and_b32 s64, s60, 3
    v_xor_b32 v26, s64, v26
    v_lshl_or_b32 v24, v26, 5, v24
    v_and_b32 v25, 3, v0
    v_lshl_or_b32 v24, v25, 3, v24
    s_lshl_b32 s64, s93, 12
    s_add_u32 s64, s64, 114688
    v_add_u32 v160, s64, v24
    v_lshrrev_b32 v24, 3, v0
    v_bfe_u32 v25, v0, 4, 2
    v_lshlrev_b32 v25, 1, v25
    v_and_b32 v26, 7, v0
    v_xor_b32 v25, v25, v26
    v_lshlrev_b32 v25, 4, v25
    v_lshl_or_b32 v29, v24, 10, v25
    s_and_b32 s64, s61, 1
    s_lshl_b32 s64, s64, 2
    s_lshr_b32 s65, s61, 1
    s_add_u32 s64, s64, s65
    s_sub_u32 s65, s62, 4
    s_lshl_b32 s66, s65, 3
    s_add_u32 s66, s66, s60
    s_lshl_b32 s66, s66, 13
    s_lshl_b32 s69, s64, 7
    s_add_u32 s85, s66, s69
    s_lshl_b32 s69, s60, 10
    s_add_u32 s94, s69, 114688
    s_mul_i32 s64, s64, 28
    s_add_u32 s64, s64, s65
    s_lshl_b32 s65, s64, 13
    s_add_u32 s65, s65, s69
    s_add_u32 s79, s65, 12845056
    s_lshl_b32 s64, s64, 7
    s_add_u32 s81, s64, 32768
    s_add_u32 m0, s74, 16384
    s_nop 0
    buffer_load_dwordx4 v7, s[40:43], s72 offen lds
    buffer_load_dwordx4 v8, s[40:43], s72 offen offset:1024 lds
    s_add_u32 s72, s72, 114688
    s_cmp_eq_u32 s72, 1835008
    s_cmov_b32 s72, 0
    s_add_u32 m0, s74, 81920
    s_nop 0
    buffer_load_dwordx4 v9, s[36:39], s73 offen lds
    buffer_load_dwordx4 v10, s[36:39], s73 offen offset:1024 lds
    s_add_u32 s73, s73, 128
    s_and_b32 s73, s73, 0x3ff
    s_add_u32 m0, s74, 32768
    s_nop 0
    buffer_load_dwordx4 v7, s[40:43], s72 offen lds
    buffer_load_dwordx4 v8, s[40:43], s72 offen offset:1024 lds
    s_add_u32 s72, s72, 114688
    s_cmp_eq_u32 s72, 1835008
    s_cmov_b32 s72, 0
    global_load_ushort v212, v218, s[6:7]
    global_load_ushort v213, v218, s[8:9]
    s_cmp_ge_u32 s60, 4
    s_cbranch_scc1 L_par_1
    global_load_ushort v214, v218, s[10:11]
    global_load_ushort v215, v218, s[12:13]
    global_load_ushort v216, v218, s[14:15]
    global_load_ushort v217, v218, s[16:17]
L_par_1:
    s_mov_b32 s64, 3230828928
    s_mov_b32 s65, 757340946
    s_cmp_lg_u32 s86, 0
    s_cmov_b32 s64, 151048905
    s_cmov_b32 s65, 1363689270
    s_cmp_lg_u32 s93, 0
    s_cselect_b32 s5, s65, s64
    s_cmp_lg_u32 s77, 0
    s_cselect_b32 s7, s65, s64
    s_bfe_u32 s4, s5, 0x80000
    s_bfe_u32 s5, s5, 0x80008
    s_bfe_u32 s6, s7, 0x80010
    s_bfe_u32 s7, s7, 0x80018
    s_lshr_b32 s66, s60, 1
    s_lshl_b32 s66, s66, 3
    s_lshr_b32 s64, s64, s66
    s_lshr_b32 s65, s65, s66
    s_and_b32 s64, s64, 0xff
    s_and_b32 s65, s65, 0xff
    s_lshl_b32 s80, s64, 9
    s_lshl_b32 s8, s65, 9
    s_waitcnt lgkmcnt(0)
    s_add_u32 s63, s63, 1
    s_xor_b32 s64, s86, 1
    s_lshl_b32 s64, s64, 4
    s_lshl_b32 s56, s56, s64
    s_and_b32 s56, s56, s88
    s_and_b32 s68, s57, s88
    s_lshl_b32 s57, s57, 16
    v_mov_b32 v23, s63
    s_cmp_ge_u32 s60, 4
    s_cbranch_scc1 L_gv
    s_waitcnt vmcnt(8)
    s_barrier
    ds_read_b64_tr_b16 v[96:97], v1 offset:0
    ds_read_b64_tr_b16 v[98:99], v1 offset:1024
    ds_read_b128 v[112:115], v3 offset:0
    ds_read_b128 v[116:119], v3 offset:2048
    ds_read_b128 v[120:123], v3 offset:4096
    ds_read_b128 v[124:127], v3 offset:6144
    ds_read_b64_tr_b16 v[100:101], v1 offset:8192
    ds_read_b64_tr_b16 v[102:103], v1 offset:9216
    ds_read_b64_tr_b16 v[104:105], v2 offset:0
    ds_read_b64_tr_b16 v[106:107], v2 offset:1024
    ds_read_b64_tr_b16 v[108:109], v2 offset:8192
    ds_read_b64_tr_b16 v[110:111], v2 offset:9216
    s_waitcnt lgkmcnt(9)
    v_mfma_f32_16x16x32_bf16 v[32:35], v[96:99], v[112:115], 0
    s_add_u32 m0, s74, 49152
    s_nop 0
    buffer_load_dwordx4 v7, s[40:43], s72 offen lds
    s_lshl_b32 s64, s71, 2
    s_waitcnt lgkmcnt(8)
    v_mfma_f32_16x16x32_bf16 v[48:51], v[96:99], v[116:119], 0
    buffer_load_dwordx4 v8, s[40:43], s72 offen offset:1024 lds
    s_add_u32 s72, s72, 114688
    s_cmp_eq_u32 s72, 1835008
    s_cmov_b32 s72, 0
    s_lshr_b32 s65, s60, 1
    s_waitcnt lgkmcnt(7)
    v_mfma_f32_16x16x32_bf16 v[64:67], v[96:99], v[120:123], 0
    s_cmp_lg_u32 s59, 0
    s_cbranch_scc1 L_cs_12
    v_mfma_f32_16x16x32_bf16 v[144:147], v[148:151], v[96:99], 0
    s_waitcnt lgkmcnt(2)
    v_mfma_f32_16x16x32_bf16 v[144:147], v[152:155], v[104:107], v[144:147]
L_cs_12:
    s_cmp_lg_u32 s59, 1
    s_cbranch_scc1 L_cs_13
    s_waitcnt lgkmcnt(4)
    s_nop 4
    v_mfma_f32_16x16x32_bf16 v[144:147], v[148:151], v[100:103], 0
    s_waitcnt lgkmcnt(0)
    v_mfma_f32_16x16x32_bf16 v[144:147], v[152:155], v[108:111], v[144:147]
L_cs_13:
    s_add_u32 s64, s64, s65
    s_waitcnt lgkmcnt(6)
    v_mfma_f32_16x16x32_bf16 v[80:83], v[96:99], v[124:127], 0
    s_waitcnt vmcnt(8) lgkmcnt(0)
    s_barrier
    ds_read_b64_tr_b16 v[96:97], v1 offset:16384
    ds_read_b64_tr_b16 v[98:99], v1 offset:17408
    s_lshl_b32 s64, s64, 4
    v_mfma_f32_16x16x32_bf16 v[36:39], v[100:103], v[112:115], 0
    ds_read_b128 v[140:143], v4 offset:6144
    s_add_u32 s64, s64, s70
    v_mfma_f32_16x16x32_bf16 v[52:55], v[100:103], v[116:119], 0
    ds_read_b128 v[136:139], v4 offset:4096
    s_add_u32 m0, s74, 0
    s_nop 0
    buffer_load_dwordx4 v7, s[40:43], s72 offen lds
    s_lshl_b32 s64, s64, 1
    v_mfma_f32_16x16x32_bf16 v[68:71], v[100:103], v[120:123], 0
    ds_read_b128 v[132:135], v4 offset:2048
    s_add_u32 s64, s64, s86
    v_mfma_f32_16x16x32_bf16 v[84:87], v[100:103], v[124:127], 0
    ds_read_b64_tr_b16 v[100:101], v1 offset:24576
    ds_read_b64_tr_b16 v[102:103], v1 offset:25600
    s_lshl_b32 s64, s64, 8
    v_mfma_f32_16x16x32_bf16 v[40:43], v[104:107], v[112:115], 0
    ds_read_b128 v[128:131], v4 offset:0
    buffer_load_dwordx4 v8, s[40:43], s72 offen offset:1024 lds
    s_add_u32 s72, s72, 114688
    s_cmp_eq_u32 s72, 1835008
    s_cmov_b32 s72, 0
    s_add_u32 s82, s64, 14680064
    v_mfma_f32_16x16x32_bf16 v[56:59], v[104:107], v[116:119], 0
    s_mul_i32 s64, s60, 7
    s_lshr_b32 s65, s64, 1
    v_mfma_f32_16x16x32_bf16 v[72:75], v[104:107], v[120:123], 0
    s_mul_i32 s66, s76, 28
    s_add_u32 s65, s65, s66
    v_mfma_f32_16x16x32_bf16 v[88:91], v[104:107], v[124:127], 0
    ds_read_b64_tr_b16 v[104:105], v2 offset:16384
    ds_read_b64_tr_b16 v[106:107], v2 offset:17408
    v_min_u32 v28, 3, v0
    v_mfma_f32_16x16x32_bf16 v[44:47], v[108:111], v[112:115], 0
    v_add_u32 v28, s65, v28
    v_lshlrev_b32 v28, 7, v28
    v_mfma_f32_16x16x32_bf16 v[60:63], v[108:111], v[116:119], 0
    s_add_u32 m0, s74, 98304
    s_nop 0
    buffer_load_dwordx4 v9, s[36:39], s73 offen lds
    v_add_u32 v28, 32768, v28
    v_mfma_f32_16x16x32_bf16 v[76:79], v[108:111], v[120:123], 0
    s_mul_i32 s65, s76, 56
    s_add_u32 s64, s64, s65
    v_mfma_f32_16x16x32_bf16 v[92:95], v[108:111], v[124:127], 0
    ds_read_b64_tr_b16 v[108:109], v2 offset:24576
    ds_read_b64_tr_b16 v[110:111], v2 offset:25600
    buffer_load_dwordx4 v10, s[36:39], s73 offen offset:1024 lds
    s_add_u32 s73, s73, 128
    s_and_b32 s73, s73, 0x3ff
    s_lshl_b32 s64, s64, 12
    s_waitcnt lgkmcnt(4)
    v_mfma_f32_16x16x32_bf16 v[32:35], v[96:99], v[128:131], v[32:35]
    s_add_u32 s78, s64, 12845056
    s_and_b32 s64, s75, 3
    v_mfma_f32_16x16x32_bf16 v[48:51], v[96:99], v[132:135], v[48:51]
    s_mov_b32 m0, s94
    s_nop 0
    buffer_load_dwordx4 v29, s[44:47], s85 offen lds
    s_lshl_b32 s64, s64, 2
    v_mfma_f32_16x16x32_bf16 v[64:67], v[96:99], v[136:139], v[64:67]
    s_cmp_lg_u32 s59, 2
    s_cbranch_scc1 L_cs_14
    v_mfma_f32_16x16x32_bf16 v[144:147], v[148:151], v[96:99], 0
    s_waitcnt lgkmcnt(2)
    v_mfma_f32_16x16x32_bf16 v[144:147], v[152:155], v[104:107], v[144:147]
L_cs_14:
    s_cmp_lg_u32 s59, 3
    s_cbranch_scc1 L_cs_15
    s_nop 5
    v_mfma_f32_16x16x32_bf16 v[144:147], v[148:151], v[100:103], 0
    s_waitcnt lgkmcnt(0)
    v_mfma_f32_16x16x32_bf16 v[144:147], v[152:155], v[108:111], v[144:147]
L_cs_15:
    s_lshr_b32 s64, 0x4040, s64
    v_mfma_f32_16x16x32_bf16 v[80:83], v[96:99], v[140:143], v[80:83]
    s_waitcnt vmcnt(9) lgkmcnt(0)
    s_barrier
    ds_read_b64_tr_b16 v[96:97], v1 offset:32768
    ds_read_b64_tr_b16 v[98:99], v1 offset:33792
    s_and_b32 s64, s64, 7
    v_mfma_f32_16x16x32_bf16 v[36:39], v[100:103], v[128:131], v[36:39]
    ds_read_b128 v[124:127], v3 offset:22528
    s_lshl_b32 s9, s64, 12
    v_mfma_f32_16x16x32_bf16 v[52:55], v[100:103], v[132:135], v[52:55]
    ds_read_b128 v[120:123], v3 offset:20480
    s_add_u32 m0, s74, 16384
    s_nop 0
    buffer_load_dwordx4 v7, s[40:43], s72 offen lds
    v_lshrrev_b32 v24, 4, v0
    v_mfma_f32_16x16x32_bf16 v[68:71], v[100:103], v[136:139], v[68:71]
    ds_read_b128 v[116:119], v3 offset:18432
    v_and_b32 v25, 0xf0, v30
    v_mfma_f32_16x16x32_bf16 v[84:87], v[100:103], v[140:143], v[84:87]
    ds_read_b64_tr_b16 v[100:101], v1 offset:40960
    ds_read_b64_tr_b16 v[102:103], v1 offset:41984
    v_lshl_add_u32 v12, v24, 16, v25
    v_mfma_f32_16x16x32_bf16 v[40:43], v[104:107], v[128:131], v[40:43]
    ds_read_b128 v[112:115], v3 offset:16384
    buffer_load_dwordx4 v8, s[40:43], s72 offen offset:1024 lds
    s_add_u32 s72, s72, 114688
    s_cmp_eq_u32 s72, 1835008
    s_cmov_b32 s72, 0
    v_lshrrev_b32 v24, 1, v0
    v_mfma_f32_16x16x32_bf16 v[56:59], v[104:107], v[132:135], v[56:59]
    v_and_b32 v25, 1, v0
    s_lshl_b32 s64, s60, 18
    v_mfma_f32_16x16x32_bf16 v[72:75], v[104:107], v[136:139], v[72:75]
    s_lshl_b32 s65, s58, 8
    s_add_u32 s64, s64, s65
    v_mfma_f32_16x16x32_bf16 v[88:91], v[104:107], v[140:143], v[88:91]
    ds_read_b64_tr_b16 v[104:105], v2 offset:32768
    ds_read_b64_tr_b16 v[106:107], v2 offset:33792
    s_add_u32 s89, s64, 1048576
    v_mfma_f32_16x16x32_bf16 v[44:47], v[108:111], v[128:131], v[44:47]
    v_mul_u32_u24 v25, 16704, v25
    v_lshl_add_u32 v24, v24, 4, v25
    v_mfma_f32_16x16x32_bf16 v[60:63], v[108:111], v[132:135], v[60:63]
    s_add_u32 m0, s74, 65536
    s_nop 0
    buffer_load_dwordx4 v9, s[36:39], s73 offen lds
    s_lshl_b32 s64, s60, 9
    v_mfma_f32_16x16x32_bf16 v[76:79], v[108:111], v[136:139], v[76:79]
    s_add_u32 s64, s64, 123936
    v_add_u32 v31, s64, v24
    v_mfma_f32_16x16x32_bf16 v[92:95], v[108:111], v[140:143], v[92:95]
    ds_read_b64_tr_b16 v[108:109], v2 offset:40960
    ds_read_b64_tr_b16 v[110:111], v2 offset:41984
    s_lshl_b32 s64, s70, 1
    s_waitcnt lgkmcnt(4)
    v_mfma_f32_16x16x32_bf16 v[32:35], v[96:99], v[112:115], v[32:35]
    buffer_load_dwordx4 v10, s[36:39], s73 offen offset:1024 lds
    s_add_u32 s73, s73, 128
    s_and_b32 s73, s73, 0x3ff
    s_add_u32 s64, s64, s86
    v_mfma_f32_16x16x32_bf16 v[48:51], v[96:99], v[116:119], v[48:51]
    s_lshl_b32 s91, s64, 8
    s_add_u32 s91, s91, 65536
    v_mfma_f32_16x16x32_bf16 v[64:67], v[96:99], v[120:123], v[64:67]
    s_mul_i32 s64, s64, 224
    s_lshl_b32 s65, s71, 2
    v_mfma_f32_16x16x32_bf16 v[80:83], v[96:99], v[124:127], v[80:83]
    s_waitcnt vmcnt(4) lgkmcnt(0)
    s_barrier
    ds_read_b64_tr_b16 v[96:97], v1 offset:49152
    ds_read_b64_tr_b16 v[98:99], v1 offset:50176
    s_lshr_b32 s66, s60, 1
    v_mfma_f32_16x16x32_bf16 v[36:39], v[100:103], v[112:115], v[36:39]
    ds_read_b128 v[140:143], v4 offset:22528
    s_add_u32 s66, s66, s65
    v_mfma_f32_16x16x32_bf16 v[52:55], v[100:103], v[116:119], v[52:55]
    ds_read_b128 v[136:139], v4 offset:20480
    ds_read_b64_tr_b16 v[156:157], v160
    s_add_u32 s65, s66, s64
    v_mfma_f32_16x16x32_bf16 v[68:71], v[100:103], v[120:123], v[68:71]
    ds_read_b128 v[132:135], v4 offset:18432
    ds_read_b64_tr_b16 v[158:159], v160 offset:2048
    s_lshl_b32 s65, s65, 10
    v_mfma_f32_16x16x32_bf16 v[84:87], v[100:103], v[124:127], v[84:87]
    ds_read_b64_tr_b16 v[100:101], v1 offset:57344
    ds_read_b64_tr_b16 v[102:103], v1 offset:58368
    v_mov_b32 v147, s63
    s_mov_b64 exec, 0xffff
    buffer_store_dwordx4 v[144:147], v30, s[52:55], s82 offen sc1
    s_mov_b64 exec, -1
    s_add_u32 s84, s65, 5505024
    v_mfma_f32_16x16x32_bf16 v[40:43], v[104:107], v[112:115], v[40:43]
    ds_read_b128 v[128:131], v4 offset:16384
    s_add_u32 m0, s74, 32768
    s_nop 0
    buffer_load_dwordx4 v7, s[40:43], s72 offen lds
    s_mul_i32 s64, s70, 14
    v_mfma_f32_16x16x32_bf16 v[56:59], v[104:107], v[116:119], v[56:59]
    buffer_load_dwordx4 v8, s[40:43], s72 offen offset:1024 lds
    s_add_u32 s72, s72, 114688
    s_cmp_eq_u32 s72, 1835008
    s_cmov_b32 s72, 0
    s_add_u32 s64, s64, s71
    v_mfma_f32_16x16x32_bf16 v[72:75], v[104:107], v[120:123], v[72:75]
    s_lshl_b32 s64, s64, 3
    s_add_u32 s64, s64, s60
    v_mfma_f32_16x16x32_bf16 v[88:91], v[104:107], v[124:127], v[88:91]
    ds_read_b64_tr_b16 v[104:105], v2 offset:49152
    ds_read_b64_tr_b16 v[106:107], v2 offset:50176
    s_lshl_b32 s64, s64, 7
    v_mfma_f32_16x16x32_bf16 v[44:47], v[108:111], v[112:115], v[44:47]
    s_add_u32 s83, s64, 229376
    s_lshl_b32 s65, s66, 9
    v_mfma_f32_16x16x32_bf16 v[60:63], v[108:111], v[116:119], v[60:63]
    s_waitcnt lgkmcnt(5)
    buffer_store_dwordx4 v[156:159], v30, s[52:55], s79 offen sc1
    s_add_u32 s90, s65, 196608
    v_mfma_f32_16x16x32_bf16 v[76:79], v[108:111], v[120:123], v[76:79]
    v_lshlrev_b32 v14, 3, v0
    v_and_b32 v6, 0xf0, v30
    v_mfma_f32_16x16x32_bf16 v[92:95], v[108:111], v[124:127], v[92:95]
    ds_read_b64_tr_b16 v[108:109], v2 offset:57344
    ds_read_b64_tr_b16 v[110:111], v2 offset:58368
    s_lshl_b32 s64, s60, 8
    s_waitcnt lgkmcnt(4)
    v_mfma_f32_16x16x32_bf16 v[32:35], v[96:99], v[128:131], v[32:35]
    s_add_u32 s92, s64, 114688
    v_lshrrev_b32 v5, 4, v0
    v_mfma_f32_16x16x32_bf16 v[48:51], v[96:99], v[132:135], v[48:51]
    v_lshl_add_u32 v5, v5, 4, s92
    v_mov_b32 v210, s56
    v_mfma_f32_16x16x32_bf16 v[64:67], v[96:99], v[136:139], v[64:67]
    s_mov_b32 s3, 0x3fb8aa3b
    v_mul_f32 v218, s3, v210
    v_mfma_f32_16x16x32_bf16 v[80:83], v[96:99], v[140:143], v[80:83]
    s_waitcnt lgkmcnt(0)
    s_barrier
    ds_read_b64_tr_b16 v[96:97], v1 offset:0
    ds_read_b64_tr_b16 v[98:99], v1 offset:1024
    v_fma_f32 v219, v210, s3, -v218
    v_mfma_f32_16x16x32_bf16 v[36:39], v[100:103], v[128:131], v[36:39]
    ds_read_b128 v[124:127], v3 offset:38912
    v_fmamk_f32 v219, v210, 0x32a57060, v219
    v_mfma_f32_16x16x32_bf16 v[52:55], v[100:103], v[132:135], v[52:55]
    ds_read_b128 v[120:123], v3 offset:36864
    s_add_u32 m0, s74, 49152
    s_nop 0
    buffer_load_dwordx4 v7, s[40:43], s72 offen lds
    v_exp_f32 v218, v218
    v_mfma_f32_16x16x32_bf16 v[68:71], v[100:103], v[136:139], v[68:71]
    ds_read_b128 v[116:119], v3 offset:34816
    v_mul_f32 v219, 0x3f317218, v219
    v_mfma_f32_16x16x32_bf16 v[84:87], v[100:103], v[140:143], v[84:87]
    ds_read_b64_tr_b16 v[100:101], v1 offset:8192
    ds_read_b64_tr_b16 v[102:103], v1 offset:9216
    v_fma_f32 v218, v218, v219, v218
    v_mfma_f32_16x16x32_bf16 v[40:43], v[104:107], v[128:131], v[40:43]
    ds_read_b128 v[112:115], v3 offset:32768
    buffer_load_dwordx4 v8, s[40:43], s72 offen offset:1024 lds
    s_add_u32 s72, s72, 114688
    s_cmp_eq_u32 s72, 1835008
    s_cmov_b32 s72, 0
    v_cvt_pk_bf16_f32 v218, v218, v218
    v_mfma_f32_16x16x32_bf16 v[56:59], v[104:107], v[132:135], v[56:59]
    v_and_b32 v218, s88, v218
    v_lshlrev_b32 v212, 16, v212
    v_mfma_f32_16x16x32_bf16 v[72:75], v[104:107], v[136:139], v[72:75]
    v_lshlrev_b32 v213, 16, v213
    v_lshlrev_b32 v214, 16, v214
    v_mfma_f32_16x16x32_bf16 v[88:91], v[104:107], v[140:143], v[88:91]
    ds_read_b64_tr_b16 v[104:105], v2 offset:0
    ds_read_b64_tr_b16 v[106:107], v2 offset:1024
    v_lshlrev_b32 v215, 16, v215
    v_mfma_f32_16x16x32_bf16 v[44:47], v[108:111], v[128:131], v[44:47]
    v_lshlrev_b32 v216, 16, v216
    v_lshlrev_b32 v217, 16, v217
    v_mfma_f32_16x16x32_bf16 v[60:63], v[108:111], v[132:135], v[60:63]
    s_add_u32 m0, s74, 81920
    s_nop 0
    buffer_load_dwordx4 v9, s[36:39], s73 offen lds
    v_mul_f32 v212, v218, v212
    v_mfma_f32_16x16x32_bf16 v[76:79], v[108:111], v[136:139], v[76:79]
    v_mul_f32 v213, v218, v213
    v_mul_f32 v212, s3, v212
    v_mfma_f32_16x16x32_bf16 v[92:95], v[108:111], v[140:143], v[92:95]
    ds_read_b64_tr_b16 v[108:109], v2 offset:8192
    ds_read_b64_tr_b16 v[110:111], v2 offset:9216
    v_mul_f32 v213, 0xbe22f983, v213
    s_waitcnt lgkmcnt(4)
    v_mfma_f32_16x16x32_bf16 v[32:35], v[96:99], v[112:115], v[32:35]
    buffer_load_dwordx4 v10, s[36:39], s73 offen offset:1024 lds
    s_add_u32 s73, s73, 128
    s_and_b32 s73, s73, 0x3ff
    v_mul_f32 v214, v218, v214
    v_mfma_f32_16x16x32_bf16 v[48:51], v[96:99], v[116:119], v[48:51]
    v_mul_f32 v215, v218, v215
    v_mul_f32 v210, 1.0, v212
    v_mfma_f32_16x16x32_bf16 v[64:67], v[96:99], v[120:123], v[64:67]
    v_mul_f32 v211, 1.0, v213
    v_exp_f32 v210, v210
    v_mfma_f32_16x16x32_bf16 v[80:83], v[96:99], v[124:127], v[80:83]
    s_waitcnt vmcnt(10) lgkmcnt(0)
    s_barrier
    ds_read_b64_tr_b16 v[96:97], v1 offset:16384
    ds_read_b64_tr_b16 v[98:99], v1 offset:17408
    v_fract_f32 v211, v211
    v_mfma_f32_16x16x32_bf16 v[36:39], v[100:103], v[112:115], v[36:39]
    ds_read_b128 v[140:143], v4 offset:38912
    v_cos_f32 v192, v211
    v_mfma_f32_16x16x32_bf16 v[52:55], v[100:103], v[116:119], v[52:55]
    ds_read_b128 v[136:139], v4 offset:36864
    s_add_u32 m0, s74, 0
    s_nop 0
    buffer_load_dwordx4 v7, s[40:43], s72 offen lds
    v_sin_f32 v193, v211
    v_mfma_f32_16x16x32_bf16 v[68:71], v[100:103], v[120:123], v[68:71]
    ds_read_b128 v[132:135], v4 offset:34816
    v_mul_f32 v192, v210, v192
    v_mfma_f32_16x16x32_bf16 v[84:87], v[100:103], v[124:127], v[84:87]
    ds_read_b64_tr_b16 v[100:101], v1 offset:24576
    ds_read_b64_tr_b16 v[102:103], v1 offset:25600
    v_mul_f32 v193, v210, v193
    v_mfma_f32_16x16x32_bf16 v[40:43], v[104:107], v[112:115], v[40:43]
    ds_read_b128 v[128:131], v4 offset:32768
    buffer_load_dwordx4 v8, s[40:43], s72 offen offset:1024 lds
    s_add_u32 s72, s72, 114688
    s_cmp_eq_u32 s72, 1835008
    s_cmov_b32 s72, 0
    v_mul_f32 v202, v214, v216
    v_mfma_f32_16x16x32_bf16 v[56:59], v[104:107], v[116:119], v[56:59]
    v_mul_f32 v203, v214, v217
    v_fma_f32 v202, -v215, v217, v202
    v_mfma_f32_16x16x32_bf16 v[72:75], v[104:107], v[120:123], v[72:75]
    v_fmac_f32 v203, v215, v216
    v_mul_f32 v210, 0x43800000, v212
    v_mfma_f32_16x16x32_bf16 v[88:91], v[104:107], v[124:127], v[88:91]
    ds_read_b64_tr_b16 v[104:105], v2 offset:16384
    ds_read_b64_tr_b16 v[106:107], v2 offset:17408
    v_mul_f32 v211, 0x43800000, v213
    v_mfma_f32_16x16x32_bf16 v[44:47], v[108:111], v[112:115], v[44:47]
    v_exp_f32 v210, v210
    v_fract_f32 v211, v211
    v_mfma_f32_16x16x32_bf16 v[60:63], v[108:111], v[116:119], v[60:63]
    v_cos_f32 v200, v211
    v_sin_f32 v201, v211
    v_mfma_f32_16x16x32_bf16 v[76:79], v[108:111], v[120:123], v[76:79]
    v_mul_f32 v200, v210, v200
    v_mul_f32 v201, v210, v201
    v_mfma_f32_16x16x32_bf16 v[92:95], v[108:111], v[124:127], v[92:95]
    ds_read_b64_tr_b16 v[108:109], v2 offset:24576
    ds_read_b64_tr_b16 v[110:111], v2 offset:25600
    v_sub_f32 v203, 0, v203
    s_waitcnt lgkmcnt(4)
    v_mfma_f32_16x16x32_bf16 v[32:35], v[96:99], v[128:131], v[32:35]
    v_mul_f32 v194, v192, v192
    v_mul_f32 v195, v192, v193
    v_mfma_f32_16x16x32_bf16 v[48:51], v[96:99], v[132:135], v[48:51]
    v_fma_f32 v194, -v193, v193, v194
    v_fmac_f32 v195, v193, v192
    v_mfma_f32_16x16x32_bf16 v[64:67], v[96:99], v[136:139], v[64:67]
    v_cvt_pk_bf16_f32 v224, v202, v203
    v_mul_f32 v196, v194, v194
    v_mfma_f32_16x16x32_bf16 v[80:83], v[96:99], v[140:143], v[80:83]
    s_waitcnt vmcnt(6) lgkmcnt(0)
    s_barrier
    ds_read_b64_tr_b16 v[96:97], v1 offset:32768
    ds_read_b64_tr_b16 v[98:99], v1 offset:33792
    v_mul_f32 v197, v194, v195
    v_mfma_f32_16x16x32_bf16 v[36:39], v[100:103], v[128:131], v[36:39]
    ds_read_b128 v[124:127], v3 offset:6144
    v_fma_f32 v196, -v195, v195, v196
    v_mfma_f32_16x16x32_bf16 v[52:55], v[100:103], v[132:135], v[52:55]
    ds_read_b128 v[120:123], v3 offset:4096
    s_cmp_lg_u32 s60, 0
    s_cbranch_scc1 L_w0_2
    buffer_store_dword v23, v13, s[52:55], s81 offen sc1
L_w0_2:
    v_fmac_f32 v197, v195, v194
    v_mfma_f32_16x16x32_bf16 v[68:71], v[100:103], v[136:139], v[68:71]
    ds_read_b128 v[116:119], v3 offset:2048
    v_mul_f32 v198, v196, v196
    v_mfma_f32_16x16x32_bf16 v[84:87], v[100:103], v[140:143], v[84:87]
    ds_read_b64_tr_b16 v[100:101], v1 offset:40960
    ds_read_b64_tr_b16 v[102:103], v1 offset:41984
    s_add_u32 m0, s74, 16384
    s_nop 0
    buffer_load_dwordx4 v7, s[40:43], s72 offen lds
    v_mul_f32 v199, v196, v197
    v_mfma_f32_16x16x32_bf16 v[40:43], v[104:107], v[128:131], v[40:43]
    ds_read_b128 v[112:115], v3 offset:0
    v_fma_f32 v198, -v197, v197, v198
    v_mfma_f32_16x16x32_bf16 v[56:59], v[104:107], v[132:135], v[56:59]
    buffer_load_dwordx4 v8, s[40:43], s72 offen offset:1024 lds
    s_add_u32 s72, s72, 114688
    s_cmp_eq_u32 s72, 1835008
    s_cmov_b32 s72, 0
    v_fmac_f32 v199, v197, v196
    v_mfma_f32_16x16x32_bf16 v[72:75], v[104:107], v[136:139], v[72:75]
    v_mul_f32 v206, v202, v192
    v_mul_f32 v207, v202, v193
    v_mfma_f32_16x16x32_bf16 v[88:91], v[104:107], v[140:143], v[88:91]
    ds_read_b64_tr_b16 v[104:105], v2 offset:32768
    ds_read_b64_tr_b16 v[106:107], v2 offset:33792
    v_fma_f32 v206, -v203, v193, v206
    v_mfma_f32_16x16x32_bf16 v[44:47], v[108:111], v[128:131], v[44:47]
    v_fmac_f32 v207, v203, v192
    v_cvt_pk_bf16_f32 v225, v206, v207
    v_mfma_f32_16x16x32_bf16 v[60:63], v[108:111], v[132:135], v[60:63]
    s_add_u32 m0, s74, 98304
    s_nop 0
    buffer_load_dwordx4 v9, s[36:39], s73 offen lds
    v_mul_f32 v208, v206, v192
    v_mfma_f32_16x16x32_bf16 v[76:79], v[108:111], v[136:139], v[76:79]
    v_mul_f32 v209, v206, v193
    v_fma_f32 v208, -v207, v193, v208
    v_mfma_f32_16x16x32_bf16 v[92:95], v[108:111], v[140:143], v[92:95]
    ds_read_b64_tr_b16 v[108:109], v2 offset:40960
    ds_read_b64_tr_b16 v[110:111], v2 offset:41984
    v_fmac_f32 v209, v207, v192
    s_waitcnt lgkmcnt(4)
    v_mfma_f32_16x16x32_bf16 v[32:35], v[96:99], v[112:115], v[32:35]
    buffer_load_dwordx4 v10, s[36:39], s73 offen offset:1024 lds
    s_add_u32 s73, s73, 128
    s_and_b32 s73, s73, 0x3ff
    v_cvt_pk_bf16_f32 v226, v208, v209
    v_mfma_f32_16x16x32_bf16 v[48:51], v[96:99], v[116:119], v[48:51]
    v_mul_f32 v206, v208, v192
    v_mul_f32 v207, v208, v193
    v_mfma_f32_16x16x32_bf16 v[64:67], v[96:99], v[120:123], v[64:67]
    v_fma_f32 v206, -v209, v193, v206
    v_fmac_f32 v207, v209, v192
    v_mfma_f32_16x16x32_bf16 v[80:83], v[96:99], v[124:127], v[80:83]
    s_waitcnt vmcnt(8) lgkmcnt(0)
    s_barrier
    ds_read_b64_tr_b16 v[96:97], v1 offset:49152
    ds_read_b64_tr_b16 v[98:99], v1 offset:50176
    v_cvt_pk_bf16_f32 v227, v206, v207
    v_mfma_f32_16x16x32_bf16 v[36:39], v[100:103], v[112:115], v[36:39]
    ds_read_b128 v[140:143], v4 offset:6144
    v_mul_f32 v208, v206, v192
    v_mfma_f32_16x16x32_bf16 v[52:55], v[100:103], v[116:119], v[52:55]
    ds_read_b128 v[136:139], v4 offset:4096
    s_add_u32 m0, s74, 32768
    s_nop 0
    buffer_load_dwordx4 v7, s[40:43], s72 offen lds
    v_mul_f32 v209, v206, v193
    v_mfma_f32_16x16x32_bf16 v[68:71], v[100:103], v[120:123], v[68:71]
    ds_read_b128 v[132:135], v4 offset:2048
    v_fma_f32 v208, -v207, v193, v208
    v_mfma_f32_16x16x32_bf16 v[84:87], v[100:103], v[124:127], v[84:87]
    ds_read_b64_tr_b16 v[100:101], v1 offset:57344
    ds_read_b64_tr_b16 v[102:103], v1 offset:58368
    v_fmac_f32 v209, v207, v192
    v_mfma_f32_16x16x32_bf16 v[40:43], v[104:107], v[112:115], v[40:43]
    ds_read_b128 v[128:131], v4 offset:0
    buffer_load_dwordx4 v8, s[40:43], s72 offen offset:1024 lds
    s_add_u32 s72, s72, 114688
    s_cmp_eq_u32 s72, 1835008
    s_cmov_b32 s72, 0
    v_cvt_pk_bf16_f32 v228, v208, v209
    v_mfma_f32_16x16x32_bf16 v[56:59], v[104:107], v[116:119], v[56:59]
    v_mul_f32 v206, v208, v192
    v_mul_f32 v207, v208, v193
    v_mfma_f32_16x16x32_bf16 v[72:75], v[104:107], v[120:123], v[72:75]
    v_fma_f32 v206, -v209, v193, v206
    v_fmac_f32 v207, v209, v192
    v_mfma_f32_16x16x32_bf16 v[88:91], v[104:107], v[124:127], v[88:91]
    ds_read_b64_tr_b16 v[104:105], v2 offset:49152
    ds_read_b64_tr_b16 v[106:107], v2 offset:50176
    v_cvt_pk_bf16_f32 v229, v206, v207
    v_mfma_f32_16x16x32_bf16 v[44:47], v[108:111], v[112:115], v[44:47]
    v_mul_f32 v208, v206, v192
    v_mul_f32 v209, v206, v193
    v_mfma_f32_16x16x32_bf16 v[60:63], v[108:111], v[116:119], v[60:63]
    v_fma_f32 v208, -v207, v193, v208
    v_fmac_f32 v209, v207, v192
    v_mfma_f32_16x16x32_bf16 v[76:79], v[108:111], v[120:123], v[76:79]
    v_cvt_pk_bf16_f32 v230, v208, v209
    v_mul_f32 v206, v208, v192
    v_mfma_f32_16x16x32_bf16 v[92:95], v[108:111], v[124:127], v[92:95]
    ds_read_b64_tr_b16 v[108:109], v2 offset:57344
    ds_read_b64_tr_b16 v[110:111], v2 offset:58368
    v_mul_f32 v207, v208, v193
    s_waitcnt lgkmcnt(4)
    v_mfma_f32_16x16x32_bf16 v[32:35], v[96:99], v[128:131], v[32:35]
    v_fma_f32 v206, -v209, v193, v206
    v_fmac_f32 v207, v209, v192
    v_mfma_f32_16x16x32_bf16 v[48:51], v[96:99], v[132:135], v[48:51]
    v_cvt_pk_bf16_f32 v231, v206, v207
    v_mul_f32 v204, v202, v200
    v_mfma_f32_16x16x32_bf16 v[64:67], v[96:99], v[136:139], v[64:67]
    v_mul_f32 v205, v202, v201
    v_fma_f32 v204, -v203, v201, v204
    v_mfma_f32_16x16x32_bf16 v[80:83], v[96:99], v[140:143], v[80:83]
    s_waitcnt vmcnt(6) lgkmcnt(0)
    s_barrier
    ds_read_b64_tr_b16 v[96:97], v1 offset:0
    ds_read_b64_tr_b16 v[98:99], v1 offset:1024
    v_fmac_f32 v205, v203, v200
    v_mfma_f32_16x16x32_bf16 v[36:39], v[100:103], v[128:131], v[36:39]
    ds_read_b128 v[124:127], v3 offset:22528
    v_cvt_pk_bf16_f32 v232, v204, v205
    v_mfma_f32_16x16x32_bf16 v[52:55], v[100:103], v[132:135], v[52:55]
    ds_read_b128 v[120:123], v3 offset:20480
    s_add_u32 m0, s74, 49152
    s_nop 0
    buffer_load_dwordx4 v7, s[40:43], s72 offen lds
    v_mul_f32 v206, v204, v194
    v_mfma_f32_16x16x32_bf16 v[68:71], v[100:103], v[136:139], v[68:71]
    ds_read_b128 v[116:119], v3 offset:18432
    v_mul_f32 v207, v204, v195
    v_mfma_f32_16x16x32_bf16 v[84:87], v[100:103], v[140:143], v[84:87]
    ds_read_b64_tr_b16 v[100:101], v1 offset:8192
    ds_read_b64_tr_b16 v[102:103], v1 offset:9216
    v_fma_f32 v206, -v205, v195, v206
    v_mfma_f32_16x16x32_bf16 v[40:43], v[104:107], v[128:131], v[40:43]
    ds_read_b128 v[112:115], v3 offset:16384
    buffer_load_dwordx4 v8, s[40:43], s72 offen offset:1024 lds
    s_add_u32 s72, s72, 114688
    s_cmp_eq_u32 s72, 1835008
    s_cmov_b32 s72, 0
    v_fmac_f32 v207, v205, v194
    v_mfma_f32_16x16x32_bf16 v[56:59], v[104:107], v[132:135], v[56:59]
    v_cvt_pk_bf16_f32 v233, v206, v207
    v_mul_f32 v208, v204, v196
    v_mfma_f32_16x16x32_bf16 v[72:75], v[104:107], v[136:139], v[72:75]
    v_mul_f32 v209, v204, v197
    v_fma_f32 v208, -v205, v197, v208
    v_mfma_f32_16x16x32_bf16 v[88:91], v[104:107], v[140:143], v[88:91]
    ds_read_b64_tr_b16 v[104:105], v2 offset:0
    ds_read_b64_tr_b16 v[106:107], v2 offset:1024
    v_fmac_f32 v209, v205, v196
    v_mfma_f32_16x16x32_bf16 v[44:47], v[108:111], v[128:131], v[44:47]
    v_cvt_pk_bf16_f32 v234, v208, v209
    v_mul_f32 v206, v208, v194
    v_mfma_f32_16x16x32_bf16 v[60:63], v[108:111], v[132:135], v[60:63]
    s_add_u32 m0, s74, 65536
    s_nop 0
    buffer_load_dwordx4 v9, s[36:39], s73 offen lds
    v_mul_f32 v207, v208, v195
    v_mfma_f32_16x16x32_bf16 v[76:79], v[108:111], v[136:139], v[76:79]
    v_fma_f32 v206, -v209, v195, v206
    v_fmac_f32 v207, v209, v194
    v_mfma_f32_16x16x32_bf16 v[92:95], v[108:111], v[140:143], v[92:95]
    ds_read_b64_tr_b16 v[108:109], v2 offset:8192
    ds_read_b64_tr_b16 v[110:111], v2 offset:9216
    v_cvt_pk_bf16_f32 v235, v206, v207
    s_waitcnt lgkmcnt(4)
    v_mfma_f32_16x16x32_bf16 v[32:35], v[96:99], v[112:115], v[32:35]
    buffer_load_dwordx4 v10, s[36:39], s73 offen offset:1024 lds
    s_add_u32 s73, s73, 128
    s_and_b32 s73, s73, 0x3ff
    v_mul_f32 v208, v204, v198
    v_mfma_f32_16x16x32_bf16 v[48:51], v[96:99], v[116:119], v[48:51]
    v_mul_f32 v209, v204, v199
    v_fma_f32 v208, -v205, v199, v208
    v_mfma_f32_16x16x32_bf16 v[64:67], v[96:99], v[120:123], v[64:67]
    v_fmac_f32 v209, v205, v198
    v_cvt_pk_bf16_f32 v236, v208, v209
    v_mfma_f32_16x16x32_bf16 v[80:83], v[96:99], v[124:127], v[80:83]
    s_waitcnt vmcnt(8) lgkmcnt(0)
    s_barrier
    ds_read_b64_tr_b16 v[96:97], v1 offset:16384
    ds_read_b64_tr_b16 v[98:99], v1 offset:17408
    v_mul_f32 v202, v204, v200
    v_mfma_f32_16x16x32_bf16 v[36:39], v[100:103], v[112:115], v[36:39]
    ds_read_b128 v[140:143], v4 offset:22528
    v_mul_f32 v203, v204, v201
    v_mfma_f32_16x16x32_bf16 v[52:55], v[100:103], v[116:119], v[52:55]
    ds_read_b128 v[136:139], v4 offset:20480
    buffer_load_dword v22, v28, s[52:55], 0 offen sc1
    v_fma_f32 v202, -v205, v201, v202
    v_mfma_f32_16x16x32_bf16 v[68:71], v[100:103], v[120:123], v[68:71]
    ds_read_b128 v[132:135], v4 offset:18432
    v_fmac_f32 v203, v205, v200
    v_mfma_f32_16x16x32_bf16 v[84:87], v[100:103], v[124:127], v[84:87]
    ds_read_b64_tr_b16 v[100:101], v1 offset:24576
    ds_read_b64_tr_b16 v[102:103], v1 offset:25600
    s_add_u32 m0, s74, 0
    s_nop 0
    buffer_load_dwordx4 v7, s[40:43], s72 offen lds
    v_cvt_pk_bf16_f32 v237, v202, v203
    v_mfma_f32_16x16x32_bf16 v[40:43], v[104:107], v[112:115], v[40:43]
    ds_read_b128 v[128:131], v4 offset:16384
    v_mul_f32 v206, v202, v196
    v_mfma_f32_16x16x32_bf16 v[56:59], v[104:107], v[116:119], v[56:59]
    buffer_load_dwordx4 v8, s[40:43], s72 offen offset:1024 lds
    s_add_u32 s72, s72, 114688
    s_cmp_eq_u32 s72, 1835008
    s_cmov_b32 s72, 0
    v_mul_f32 v207, v202, v197
    v_mfma_f32_16x16x32_bf16 v[72:75], v[104:107], v[120:123], v[72:75]
    v_fma_f32 v206, -v203, v197, v206
    v_fmac_f32 v207, v203, v196
    v_mfma_f32_16x16x32_bf16 v[88:91], v[104:107], v[124:127], v[88:91]
    ds_read_b64_tr_b16 v[104:105], v2 offset:16384
    ds_read_b64_tr_b16 v[106:107], v2 offset:17408
    v_cvt_pk_bf16_f32 v238, v206, v207
    v_mfma_f32_16x16x32_bf16 v[44:47], v[108:111], v[112:115], v[44:47]
    v_mul_f32 v208, v202, v198
    v_mul_f32 v209, v202, v199
    v_mfma_f32_16x16x32_bf16 v[60:63], v[108:111], v[116:119], v[60:63]
    v_fma_f32 v208, -v203, v199, v208
    v_fmac_f32 v209, v203, v198
    v_mfma_f32_16x16x32_bf16 v[76:79], v[108:111], v[120:123], v[76:79]
    v_cvt_pk_bf16_f32 v239, v208, v209
    v_mul_f32 v204, v202, v200
    v_mfma_f32_16x16x32_bf16 v[92:95], v[108:111], v[124:127], v[92:95]
    ds_read_b64_tr_b16 v[108:109], v2 offset:24576
    ds_read_b64_tr_b16 v[110:111], v2 offset:25600
    v_mul_f32 v205, v202, v201
    s_waitcnt lgkmcnt(4)
    v_mfma_f32_16x16x32_bf16 v[32:35], v[96:99], v[128:131], v[32:35]
    v_fma_f32 v204, -v203, v201, v204
    v_fmac_f32 v205, v203, v200
    v_mfma_f32_16x16x32_bf16 v[48:51], v[96:99], v[132:135], v[48:51]
    v_cvt_pk_bf16_f32 v240, v204, v205
    v_mul_f32 v206, v204, v196
    v_mfma_f32_16x16x32_bf16 v[64:67], v[96:99], v[136:139], v[64:67]
    v_mul_f32 v207, v204, v197
    v_fma_f32 v206, -v205, v197, v206
    v_mfma_f32_16x16x32_bf16 v[80:83], v[96:99], v[140:143], v[80:83]
    s_waitcnt vmcnt(7) lgkmcnt(0)
    s_barrier
    ds_read_b64_tr_b16 v[96:97], v1 offset:32768
    ds_read_b64_tr_b16 v[98:99], v1 offset:33792
    v_fmac_f32 v207, v205, v196
    v_mfma_f32_16x16x32_bf16 v[36:39], v[100:103], v[128:131], v[36:39]
    ds_read_b128 v[124:127], v3 offset:38912
    v_cvt_pk_bf16_f32 v241, v206, v207
    v_mfma_f32_16x16x32_bf16 v[52:55], v[100:103], v[132:135], v[52:55]
    ds_read_b128 v[120:123], v3 offset:36864
    s_add_u32 m0, s74, 16384
    s_nop 0
    buffer_load_dwordx4 v7, s[40:43], s72 offen lds
    v_mul_f32 v208, v204, v198
    v_mfma_f32_16x16x32_bf16 v[68:71], v[100:103], v[136:139], v[68:71]
    ds_read_b128 v[116:119], v3 offset:34816
    v_mul_f32 v209, v204, v199
    v_mfma_f32_16x16x32_bf16 v[84:87], v[100:103], v[140:143], v[84:87]
    ds_read_b64_tr_b16 v[100:101], v1 offset:40960
    ds_read_b64_tr_b16 v[102:103], v1 offset:41984
    v_fma_f32 v208, -v205, v199, v208
    v_mfma_f32_16x16x32_bf16 v[40:43], v[104:107], v[128:131], v[40:43]
    ds_read_b128 v[112:115], v3 offset:32768
    buffer_load_dwordx4 v8, s[40:43], s72 offen offset:1024 lds
    s_add_u32 s72, s72, 114688
    s_cmp_eq_u32 s72, 1835008
    s_cmov_b32 s72, 0
    v_fmac_f32 v209, v205, v198
    v_mfma_f32_16x16x32_bf16 v[56:59], v[104:107], v[132:135], v[56:59]
    v_cvt_pk_bf16_f32 v242, v208, v209
    v_mul_f32 v202, v204, v200
    v_mfma_f32_16x16x32_bf16 v[72:75], v[104:107], v[136:139], v[72:75]
    v_mul_f32 v203, v204, v201
    v_fma_f32 v202, -v205, v201, v202
    v_mfma_f32_16x16x32_bf16 v[88:91], v[104:107], v[140:143], v[88:91]
    ds_read_b64_tr_b16 v[104:105], v2 offset:32768
    ds_read_b64_tr_b16 v[106:107], v2 offset:33792
    v_fmac_f32 v203, v205, v200
    v_mfma_f32_16x16x32_bf16 v[44:47], v[108:111], v[128:131], v[44:47]
    v_cvt_pk_bf16_f32 v243, v202, v203
    v_mul_f32 v206, v202, v198
    v_mfma_f32_16x16x32_bf16 v[60:63], v[108:111], v[132:135], v[60:63]
    s_waitcnt vmcnt(4)
    v_cmp_ne_u32 s[100:101], s63, v22
    s_nop 0
    s_cmp_lg_u64 s[100:101], 0
    s_cbranch_scc1 L_slow_3
L_back_4:
    s_add_u32 m0, s74, 81920
    s_nop 0
    buffer_load_dwordx4 v9, s[36:39], s73 offen lds
    v_mul_f32 v207, v202, v199
    v_mfma_f32_16x16x32_bf16 v[76:79], v[108:111], v[136:139], v[76:79]
    v_fma_f32 v206, -v203, v199, v206
    v_fmac_f32 v207, v203, v198
    v_mfma_f32_16x16x32_bf16 v[92:95], v[108:111], v[140:143], v[92:95]
    ds_read_b64_tr_b16 v[108:109], v2 offset:40960
    ds_read_b64_tr_b16 v[110:111], v2 offset:41984
    v_cvt_pk_bf16_f32 v244, v206, v207
    s_waitcnt lgkmcnt(4)
    v_mfma_f32_16x16x32_bf16 v[32:35], v[96:99], v[112:115], v[32:35]
    buffer_load_dwordx4 v10, s[36:39], s73 offen offset:1024 lds
    s_add_u32 s73, s73, 128
    s_and_b32 s73, s73, 0x3ff
    v_mul_f32 v204, v202, v200
    v_mfma_f32_16x16x32_bf16 v[48:51], v[96:99], v[116:119], v[48:51]
    v_mul_f32 v205, v202, v201
    v_fma_f32 v204, -v203, v201, v204
    v_mfma_f32_16x16x32_bf16 v[64:67], v[96:99], v[120:123], v[64:67]
    v_fmac_f32 v205, v203, v200
    v_cvt_pk_bf16_f32 v245, v204, v205
    v_mfma_f32_16x16x32_bf16 v[80:83], v[96:99], v[124:127], v[80:83]
    s_waitcnt lgkmcnt(0)
    s_barrier
    ds_read_b64_tr_b16 v[96:97], v1 offset:49152
    ds_read_b64_tr_b16 v[98:99], v1 offset:50176
    s_lshr_b32 s65, s91, 8
    v_mfma_f32_16x16x32_bf16 v[36:39], v[100:103], v[112:115], v[36:39]
    ds_read_b128 v[140:143], v4 offset:38912
    s_and_b32 s65, s65, 31
    v_mfma_f32_16x16x32_bf16 v[52:55], v[100:103], v[116:119], v[52:55]
    ds_read_b128 v[136:139], v4 offset:36864
    s_add_u32 m0, s74, 32768
    s_nop 0
    buffer_load_dwordx4 v7, s[40:43], s72 offen lds
    s_lshl_b32 s64, s60, 2
    v_mfma_f32_16x16x32_bf16 v[68:71], v[100:103], v[120:123], v[68:71]
    ds_read_b128 v[132:135], v4 offset:34816
    v_add_u32 v28, s64, v0
    v_mfma_f32_16x16x32_bf16 v[84:87], v[100:103], v[124:127], v[84:87]
    ds_read_b64_tr_b16 v[100:101], v1 offset:57344
    ds_read_b64_tr_b16 v[102:103], v1 offset:58368
    buffer_load_dwordx4 v8, s[40:43], s72 offen offset:1024 lds
    s_add_u32 s72, s72, 114688
    s_cmp_eq_u32 s72, 1835008
    s_cmov_b32 s72, 0
    v_min_u32 v28, 31, v28
    v_mfma_f32_16x16x32_bf16 v[40:43], v[104:107], v[112:115], v[40:43]
    ds_read_b128 v[128:131], v4 offset:32768
    v_mov_b32 v24, s65
    v_mfma_f32_16x16x32_bf16 v[56:59], v[104:107], v[116:119], v[56:59]
    s_add_u32 s79, s78, s9
    buffer_load_dwordx4 v[144:147], v30, s[52:55], s79 offen offset:0 sc1
    v_cmp_gt_u32 vcc, 5, v0
    v_mfma_f32_16x16x32_bf16 v[72:75], v[104:107], v[120:123], v[72:75]
    s_nop 0
    v_cndmask_b32 v28, v24, v28, vcc
    v_lshlrev_b32 v28, 7, v28
    v_mfma_f32_16x16x32_bf16 v[88:91], v[104:107], v[124:127], v[88:91]
    ds_read_b64_tr_b16 v[104:105], v2 offset:49152
    ds_read_b64_tr_b16 v[106:107], v2 offset:50176
    v_add_u32 v28, 102400, v28
    v_mfma_f32_16x16x32_bf16 v[44:47], v[108:111], v[112:115], v[44:47]
    v_mul_f32 v206, v204, v198
    v_mul_f32 v207, v204, v199
    v_mfma_f32_16x16x32_bf16 v[60:63], v[108:111], v[116:119], v[60:63]
    buffer_load_dwordx4 v[148:151], v30, s[52:55], s79 offen offset:1024 sc1
    v_fma_f32 v206, -v205, v199, v206
    v_mfma_f32_16x16x32_bf16 v[76:79], v[108:111], v[120:123], v[76:79]
    v_fmac_f32 v207, v205, v198
    v_cvt_pk_bf16_f32 v246, v206, v207
    v_mfma_f32_16x16x32_bf16 v[92:95], v[108:111], v[124:127], v[92:95]
    ds_read_b64_tr_b16 v[108:109], v2 offset:57344
    ds_read_b64_tr_b16 v[110:111], v2 offset:58368
    v_mul_f32 v202, v204, v200
    s_waitcnt lgkmcnt(4)
    v_mfma_f32_16x16x32_bf16 v[32:35], v[96:99], v[128:131], v[32:35]
    v_mul_f32 v203, v204, v201
    v_fma_f32 v202, -v205, v201, v202
    v_mfma_f32_16x16x32_bf16 v[48:51], v[96:99], v[132:135], v[48:51]
    v_fmac_f32 v203, v205, v200
    v_cvt_pk_bf16_f32 v247, v202, v203
    v_mfma_f32_16x16x32_bf16 v[64:67], v[96:99], v[136:139], v[64:67]
    v_mul_f32 v206, v202, v198
    v_mul_f32 v207, v202, v199
    v_mfma_f32_16x16x32_bf16 v[80:83], v[96:99], v[140:143], v[80:83]
    s_waitcnt vmcnt(8) lgkmcnt(0)
    s_barrier
    ds_read_b64_tr_b16 v[96:97], v1 offset:0
    ds_read_b64_tr_b16 v[98:99], v1 offset:1024
    v_fma_f32 v206, -v203, v199, v206
    v_mfma_f32_16x16x32_bf16 v[36:39], v[100:103], v[128:131], v[36:39]
    ds_read_b128 v[124:127], v3 offset:6144
    v_fmac_f32 v207, v203, v198
    v_mfma_f32_16x16x32_bf16 v[52:55], v[100:103], v[132:135], v[52:55]
    ds_read_b128 v[120:123], v3 offset:4096
    buffer_load_dword v22, v28, s[52:55], 0 offen sc1
    v_cvt_pk_bf16_f32 v248, v206, v207
    v_mfma_f32_16x16x32_bf16 v[68:71], v[100:103], v[136:139], v[68:71]
    ds_read_b128 v[116:119], v3 offset:2048
    s_add_u32 m0, s74, 49152
    s_nop 0
    buffer_load_dwordx4 v7, s[40:43], s72 offen lds
    v_mul_f32 v204, v202, v200
    v_mfma_f32_16x16x32_bf16 v[84:87], v[100:103], v[140:143], v[84:87]
    ds_read_b64_tr_b16 v[100:101], v1 offset:8192
    ds_read_b64_tr_b16 v[102:103], v1 offset:9216
    v_mul_f32 v205, v202, v201
    v_mfma_f32_16x16x32_bf16 v[40:43], v[104:107], v[128:131], v[40:43]
    ds_read_b128 v[112:115], v3 offset:0
    buffer_load_dwordx4 v8, s[40:43], s72 offen offset:1024 lds
    s_add_u32 s72, s72, 114688
    s_cmp_eq_u32 s72, 1835008
    s_cmov_b32 s72, 0
    v_fma_f32 v204, -v203, v201, v204
    v_mfma_f32_16x16x32_bf16 v[56:59], v[104:107], v[132:135], v[56:59]
    buffer_load_dwordx4 v[152:155], v30, s[52:55], s79 offen offset:2048 sc1
    v_fmac_f32 v205, v203, v200
    v_mfma_f32_16x16x32_bf16 v[72:75], v[104:107], v[136:139], v[72:75]
    v_cvt_pk_bf16_f32 v249, v204, v205
    v_mul_f32 v206, v204, v198
    v_mfma_f32_16x16x32_bf16 v[88:91], v[104:107], v[140:143], v[88:91]
    ds_read_b64_tr_b16 v[104:105], v2 offset:0
    ds_read_b64_tr_b16 v[106:107], v2 offset:1024
    v_mul_f32 v207, v204, v199
    v_mfma_f32_16x16x32_bf16 v[44:47], v[108:111], v[128:131], v[44:47]
    v_fma_f32 v206, -v205, v199, v206
    v_fmac_f32 v207, v205, v198
    v_mfma_f32_16x16x32_bf16 v[60:63], v[108:111], v[132:135], v[60:63]
    buffer_load_dwordx4 v[156:159], v30, s[52:55], s79 offen offset:3072 sc1
    s_add_u32 s9, s9, 4096
    s_cmp_eq_u32 s9, 28672
    s_cmov_b32 s9, 0
    v_cvt_pk_bf16_f32 v250, v206, v207
    v_mfma_f32_16x16x32_bf16 v[76:79], v[108:111], v[136:139], v[76:79]
    v_lshl_add_u32 v29, v0, 2, s92
    v_and_b32 v24, 15, v0
    v_mfma_f32_16x16x32_bf16 v[92:95], v[108:111], v[140:143], v[92:95]
    ds_read_b64_tr_b16 v[108:109], v2 offset:8192
    ds_read_b64_tr_b16 v[110:111], v2 offset:9216
    v_lshrrev_b32 v25, 4, v0
    s_waitcnt lgkmcnt(4)
    v_mfma_f32_16x16x32_bf16 v[32:35], v[96:99], v[112:115], v[32:35]
    s_add_u32 s79, s78, s9
    buffer_load_dwordx4 v[160:163], v30, s[52:55], s79 offen offset:0 sc1
    v_mul_u32_u24 v220, 288, v24
    v_mfma_f32_16x16x32_bf16 v[48:51], v[96:99], v[116:119], v[48:51]
    v_lshl_add_u32 v220, v25, 4, v220
    v_lshl_add_u32 v208, s4, 9, v220
    v_mfma_f32_16x16x32_bf16 v[64:67], v[96:99], v[120:123], v[64:67]
    v_lshl_add_u32 v209, s5, 9, v220
    v_lshl_add_u32 v210, s6, 9, v220
    v_mfma_f32_16x16x32_bf16 v[80:83], v[96:99], v[124:127], v[80:83]
    s_waitcnt vmcnt(12) lgkmcnt(0)
    s_barrier
    ds_read_b64_tr_b16 v[96:97], v1 offset:16384
    ds_read_b64_tr_b16 v[98:99], v1 offset:17408
    v_lshl_add_u32 v211, s7, 9, v220
    v_mfma_f32_16x16x32_bf16 v[36:39], v[100:103], v[112:115], v[36:39]
    ds_read_b128 v[140:143], v4 offset:6144
    v_add_u32 v220, 1, v24
    v_mfma_f32_16x16x32_bf16 v[52:55], v[100:103], v[116:119], v[52:55]
    ds_read_b128 v[136:139], v4 offset:4096
    buffer_load_dwordx2 v[20:21], v14, s[52:55], s90 offen sc1
    v_and_b32 v221, 3, v220
    v_mfma_f32_16x16x32_bf16 v[68:71], v[100:103], v[120:123], v[68:71]
    ds_read_b128 v[132:135], v4 offset:2048
    v_sub_u32 v220, v220, v221
    v_mfma_f32_16x16x32_bf16 v[84:87], v[100:103], v[124:127], v[84:87]
    ds_read_b64_tr_b16 v[100:101], v1 offset:24576
    ds_read_b64_tr_b16 v[102:103], v1 offset:25600
    v_lshl_add_u32 v220, v25, 3, v220
    v_mfma_f32_16x16x32_bf16 v[40:43], v[104:107], v[112:115], v[40:43]
    ds_read_b128 v[128:131], v4 offset:0
    buffer_load_dwordx4 v[164:167], v30, s[52:55], s79 offen offset:1024 sc1
    v_mul_u32_u24 v221, 4160, v221
    v_mfma_f32_16x16x32_bf16 v[56:59], v[104:107], v[116:119], v[56:59]
    v_lshl_add_u32 v218, v220, 1, v221
    v_lshlrev_b32 v220, 5, v24
    v_mfma_f32_16x16x32_bf16 v[72:75], v[104:107], v[120:123], v[72:75]
    v_lshlrev_b32 v221, 4, v25
    v_sub_u32 v219, v221, v220
    v_mfma_f32_16x16x32_bf16 v[88:91], v[104:107], v[124:127], v[88:91]
    ds_read_b64_tr_b16 v[104:105], v2 offset:16384
    ds_read_b64_tr_b16 v[106:107], v2 offset:17408
    v_lshl_add_u32 v24, s77, 4, v24
    v_mfma_f32_16x16x32_bf16 v[44:47], v[108:111], v[112:115], v[44:47]
    s_mul_i32 s64, s86, 4608
    s_add_u32 s65, s64, 118784
    v_mfma_f32_16x16x32_bf16 v[60:63], v[108:111], v[116:119], v[60:63]
    s_waitcnt vmcnt(7)
    v_cmp_ne_u32 s[100:101], s63, v22
    s_nop 0
    s_cmp_lg_u64 s[100:101], 0
    s_cbranch_scc1 L_slow_6
L_back_7:
    buffer_load_dwordx4 v[16:19], v6, s[52:55], s91 offen sc1
    v_lshl_add_u32 v212, v13, 2, s65
    v_mfma_f32_16x16x32_bf16 v[76:79], v[108:111], v[120:123], v[76:79]
    v_mov_b32 v220, 0
    v_mov_b32 v221, 0
    v_mfma_f32_16x16x32_bf16 v[92:95], v[108:111], v[124:127], v[92:95]
    ds_read_b64_tr_b16 v[108:109], v2 offset:24576
    ds_read_b64_tr_b16 v[110:111], v2 offset:25600
    v_mov_b32 v222, 0
    s_waitcnt lgkmcnt(4)
    v_mfma_f32_16x16x32_bf16 v[32:35], v[96:99], v[128:131], v[32:35]
    buffer_load_dwordx4 v[168:171], v30, s[52:55], s79 offen offset:2048 sc1
    v_mov_b32 v223, 0
    v_mfma_f32_16x16x32_bf16 v[48:51], v[96:99], v[132:135], v[48:51]
    ds_write_b128 v212, v[220:223]
    v_lshrrev_b32 v212, 1, v25
    v_mfma_f32_16x16x32_bf16 v[64:67], v[96:99], v[136:139], v[64:67]
    v_lshlrev_b32 v212, 9, v212
    v_lshl_add_u32 v212, v24, 4, v212
    v_and_b32 v25, 1, v25
    v_lshl_add_u32 v212, v25, 3, v212
    s_add_u32 s65, s64, 118776
    v_sub_u32 v212, s65, v212
    v_mfma_f32_16x16x32_bf16 v[80:83], v[96:99], v[140:143], v[80:83]
    s_waitcnt lgkmcnt(0)
    s_barrier
    ds_read_b64_tr_b16 v[96:97], v1 offset:32768
    ds_read_b64_tr_b16 v[98:99], v1 offset:33792
    v_mfma_f32_16x16x32_bf16 v[36:39], v[100:103], v[128:131], v[36:39]
    ds_read_b128 v[124:127], v3 offset:22528
    v_mfma_f32_16x16x32_bf16 v[52:55], v[100:103], v[132:135], v[52:55]
    ds_read_b128 v[120:123], v3 offset:20480
    buffer_load_dwordx4 v[8:11], v12, s[52:55], s89 offen sc1
    s_add_u32 s95, s89, 65312
    v_mfma_f32_16x16x32_bf16 v[68:71], v[100:103], v[136:139], v[68:71]
    ds_read_b128 v[116:119], v3 offset:18432
    v_mfma_f32_16x16x32_bf16 v[84:87], v[100:103], v[140:143], v[84:87]
    ds_read_b64_tr_b16 v[100:101], v1 offset:40960
    ds_read_b64_tr_b16 v[102:103], v1 offset:41984
    s_mov_b32 exec_lo, 0xc000c000
    s_mov_b32 exec_hi, 0xc000c000
    buffer_load_dwordx2 v[26:27], v12, s[52:55], s95 offen sc1
    s_mov_b64 exec, -1
    v_mfma_f32_16x16x32_bf16 v[40:43], v[104:107], v[128:131], v[40:43]
    ds_read_b128 v[112:115], v3 offset:16384
    v_mfma_f32_16x16x32_bf16 v[56:59], v[104:107], v[132:135], v[56:59]
    buffer_load_dwordx4 v[172:175], v30, s[52:55], s79 offen offset:3072 sc1
    s_add_u32 s9, s9, 4096
    s_cmp_eq_u32 s9, 28672
    s_cmov_b32 s9, 0
    v_mfma_f32_16x16x32_bf16 v[72:75], v[104:107], v[136:139], v[72:75]
    v_mfma_f32_16x16x32_bf16 v[88:91], v[104:107], v[140:143], v[88:91]
    ds_read_b64_tr_b16 v[104:105], v2 offset:32768
    ds_read_b64_tr_b16 v[106:107], v2 offset:33792
    v_mfma_f32_16x16x32_bf16 v[44:47], v[108:111], v[128:131], v[44:47]
    v_mfma_f32_16x16x32_bf16 v[60:63], v[108:111], v[132:135], v[60:63]
    s_waitcnt vmcnt(6)
    v_cmp_ne_u32 s[100:101], s63, v21
    s_nop 0
    s_cmp_lg_u64 s[100:101], 0
    s_cbranch_scc1 L_slow_9
L_back_10:
    ds_write_b32 v29, v20
    v_mfma_f32_16x16x32_bf16 v[76:79], v[108:111], v[136:139], v[76:79]
    v_mfma_f32_16x16x32_bf16 v[92:95], v[108:111], v[140:143], v[92:95]
    ds_read_b64_tr_b16 v[108:109], v2 offset:40960
    ds_read_b64_tr_b16 v[110:111], v2 offset:41984
    s_waitcnt lgkmcnt(5)
    v_mfma_f32_16x16x32_bf16 v[32:35], v[96:99], v[112:115], v[32:35]
    s_add_u32 s79, s78, s9
    buffer_load_dwordx4 v[176:179], v30, s[52:55], s79 offen offset:0 sc1
    v_mfma_f32_16x16x32_bf16 v[36:39], v[100:103], v[112:115], v[36:39]
    s_waitcnt lgkmcnt(3)
    v_mfma_f32_16x16x32_bf16 v[40:43], v[104:107], v[112:115], v[40:43]
    s_waitcnt lgkmcnt(0)
    v_mfma_f32_16x16x32_bf16 v[44:47], v[108:111], v[112:115], v[44:47]
    s_barrier
    ds_read_b64_tr_b16 v[128:129], v1 offset:49152
    ds_read_b64_tr_b16 v[130:131], v1 offset:50176
    v_mfma_f32_16x16x32_bf16 v[48:51], v[96:99], v[116:119], v[48:51]
    ds_read_b64_tr_b16 v[132:133], v1 offset:57344
    ds_read_b64_tr_b16 v[134:135], v1 offset:58368
    ds_read_b128 v[112:115], v4 offset:16384
    v_mfma_f32_16x16x32_bf16 v[52:55], v[100:103], v[116:119], v[52:55]
    ds_read_b64_tr_b16 v[136:137], v2 offset:49152
    ds_read_b64_tr_b16 v[138:139], v2 offset:50176
    ds_read_b128 v[192:195], v5 offset:0
    v_mfma_f32_16x16x32_bf16 v[56:59], v[104:107], v[116:119], v[56:59]
    ds_read_b64_tr_b16 v[140:141], v2 offset:57344
    ds_read_b64_tr_b16 v[142:143], v2 offset:58368
    ds_read_b128 v[196:199], v5 offset:64
    v_mfma_f32_16x16x32_bf16 v[60:63], v[108:111], v[116:119], v[60:63]
    ds_read_b128 v[200:203], v5 offset:128
    s_mov_b32 m0, s80
    s_nop 0
    ds_write_addtid_b32 v224 offset:0
    ds_write_addtid_b32 v225 offset:288
    s_waitcnt lgkmcnt(9)
    v_mfma_f32_16x16x32_bf16 v[32:35], v[128:131], v[112:115], v[32:35]
    ds_read_b128 v[116:119], v4 offset:18432
    ds_read_b128 v[204:207], v5 offset:192
    ds_write_addtid_b32 v226 offset:576
    ds_write_addtid_b32 v227 offset:864
    ds_write_addtid_b32 v228 offset:1152
    v_mfma_f32_16x16x32_bf16 v[36:39], v[132:135], v[112:115], v[36:39]
    buffer_load_dwordx4 v[180:183], v30, s[52:55], s79 offen offset:1024 sc1
    ds_write_addtid_b32 v229 offset:1440
    ds_write_addtid_b32 v230 offset:1728
    ds_write_addtid_b32 v231 offset:2016
    s_waitcnt lgkmcnt(15)
    v_mfma_f32_16x16x32_bf16 v[40:43], v[136:139], v[112:115], v[40:43]
    buffer_load_dwordx4 v[184:187], v30, s[52:55], s79 offen offset:2048 sc1
    ds_write_addtid_b32 v232 offset:2304
    ds_write_addtid_b32 v232 offset:2592
    ds_write_addtid_b32 v233 offset:2880
    s_waitcnt lgkmcnt(15)
    v_mfma_f32_16x16x32_bf16 v[44:47], v[140:143], v[112:115], v[44:47]
    ds_write_addtid_b32 v234 offset:3168
    ds_write_addtid_b32 v234 offset:3456
    ds_write_addtid_b32 v234 offset:3744
    s_waitcnt lgkmcnt(13)
    v_mfma_f32_16x16x32_bf16 v[48:51], v[128:131], v[116:119], v[48:51]
    ds_read_b128 v[112:115], v4 offset:20480
    ds_write_addtid_b32 v235 offset:4032
    ds_write_addtid_b32 v236 offset:4320
    s_mov_b32 m0, s8
    v_mfma_f32_16x16x32_bf16 v[52:55], v[132:135], v[116:119], v[52:55]
    buffer_load_dwordx4 v[188:191], v30, s[52:55], s79 offen offset:3072 sc1
    s_add_u32 s9, s9, 4096
    s_cmp_eq_u32 s9, 28672
    s_cmov_b32 s9, 0
    ds_write_addtid_b32 v237 offset:0
    ds_write_addtid_b32 v238 offset:288
    ds_write_addtid_b32 v239 offset:576
    v_mfma_f32_16x16x32_bf16 v[56:59], v[136:139], v[116:119], v[56:59]
    s_waitcnt vmcnt(8)
    v_fma_f32 v32, -v192, v16, v32
    v_fma_f32 v33, -v193, v16, v33
    v_fma_f32 v34, -v194, v16, v34
    v_mfma_f32_16x16x32_bf16 v[60:63], v[140:143], v[116:119], v[60:63]
    v_fma_f32 v35, -v195, v16, v35
    v_fma_f32 v36, -v196, v16, v36
    v_fma_f32 v37, -v197, v16, v37
    v_mfma_f32_16x16x32_bf16 v[64:67], v[96:99], v[120:123], v[64:67]
    ds_read_b128 v[116:119], v4 offset:22528
    v_fma_f32 v38, -v198, v16, v38
    v_fma_f32 v39, -v199, v16, v39
    v_fma_f32 v40, -v200, v16, v40
    v_mfma_f32_16x16x32_bf16 v[68:71], v[100:103], v[120:123], v[68:71]
    v_fma_f32 v41, -v201, v16, v41
    v_fma_f32 v42, -v202, v16, v42
    v_fma_f32 v43, -v203, v16, v43
    v_mfma_f32_16x16x32_bf16 v[72:75], v[104:107], v[120:123], v[72:75]
    s_waitcnt lgkmcnt(15)
    v_fma_f32 v44, -v204, v16, v44
    v_fma_f32 v45, -v205, v16, v45
    v_fma_f32 v46, -v206, v16, v46
    v_mfma_f32_16x16x32_bf16 v[76:79], v[108:111], v[120:123], v[76:79]
    v_fma_f32 v47, -v207, v16, v47
    v_max_f32 v32, 0, v32
    v_max_f32 v33, 0, v33
    s_waitcnt lgkmcnt(6)
    v_mfma_f32_16x16x32_bf16 v[64:67], v[128:131], v[112:115], v[64:67]
    v_max_f32 v34, 0, v34
    v_max_f32 v35, 0, v35
    v_max_f32 v40, 0, v40
    v_mfma_f32_16x16x32_bf16 v[68:71], v[132:135], v[112:115], v[68:71]
    v_max_f32 v41, 0, v41
    v_max_f32 v42, 0, v42
    v_max_f32 v43, 0, v43
    v_mfma_f32_16x16x32_bf16 v[72:75], v[136:139], v[112:115], v[72:75]
    v_mul_f32 v32, v32, v36
    v_mul_f32 v33, v33, v37
    v_mul_f32 v34, v34, v38
    v_mfma_f32_16x16x32_bf16 v[76:79], v[140:143], v[112:115], v[76:79]
    v_mul_f32 v35, v35, v39
    v_mul_f32 v40, v40, v44
    v_mul_f32 v41, v41, v45
    s_setprio 2
    v_mfma_f32_16x16x32_bf16 v[80:83], v[96:99], v[124:127], v[80:83]
    v_mul_f32 v42, v42, v46
    v_mul_f32 v43, v43, v47
    v_cvt_pk_bf16_f32 v32, v32, v33
    v_mfma_f32_16x16x32_bf16 v[84:87], v[100:103], v[124:127], v[84:87]
    v_cvt_pk_bf16_f32 v33, v34, v35
    v_cvt_pk_bf16_f32 v34, v40, v41
    v_cvt_pk_bf16_f32 v35, v42, v43
    v_mfma_f32_16x16x32_bf16 v[88:91], v[104:107], v[124:127], v[88:91]
    buffer_store_dwordx4 v[32:35], v30, s[52:55], s84 offen sc1
    s_add_u32 s84, s84, 57344
    v_pk_fma_f32 v[48:49], v[192:193], v[16:17], v[48:49] op_sel:[0,1,0] op_sel_hi:[1,1,1] neg_lo:[0,1,0] neg_hi:[0,1,0]
    v_mfma_f32_16x16x32_bf16 v[92:95], v[108:111], v[124:127], v[92:95]
    v_pk_fma_f32 v[50:51], v[194:195], v[16:17], v[50:51] op_sel:[0,1,0] op_sel_hi:[1,1,1] neg_lo:[0,1,0] neg_hi:[0,1,0]
    v_pk_fma_f32 v[52:53], v[196:197], v[16:17], v[52:53] op_sel:[0,1,0] op_sel_hi:[1,1,1] neg_lo:[0,1,0] neg_hi:[0,1,0]
    v_pk_fma_f32 v[54:55], v[198:199], v[16:17], v[54:55] op_sel:[0,1,0] op_sel_hi:[1,1,1] neg_lo:[0,1,0] neg_hi:[0,1,0]
    s_waitcnt lgkmcnt(0)
    v_mfma_f32_16x16x32_bf16 v[80:83], v[128:131], v[116:119], v[80:83]
    v_pk_fma_f32 v[56:57], v[200:201], v[16:17], v[56:57] op_sel:[0,1,0] op_sel_hi:[1,1,1] neg_lo:[0,1,0] neg_hi:[0,1,0]
    v_pk_fma_f32 v[58:59], v[202:203], v[16:17], v[58:59] op_sel:[0,1,0] op_sel_hi:[1,1,1] neg_lo:[0,1,0] neg_hi:[0,1,0]
    v_pk_fma_f32 v[60:61], v[204:205], v[16:17], v[60:61] op_sel:[0,1,0] op_sel_hi:[1,1,1] neg_lo:[0,1,0] neg_hi:[0,1,0]
    v_mfma_f32_16x16x32_bf16 v[84:87], v[132:135], v[116:119], v[84:87]
    v_pk_fma_f32 v[62:63], v[206:207], v[16:17], v[62:63] op_sel:[0,1,0] op_sel_hi:[1,1,1] neg_lo:[0,1,0] neg_hi:[0,1,0]
    v_max_f32 v48, 0, v48
    v_max_f32 v49, 0, v49
    v_mfma_f32_16x16x32_bf16 v[88:91], v[136:139], v[116:119], v[88:91]
    v_max_f32 v50, 0, v50
    v_max_f32 v51, 0, v51
    v_max_f32 v56, 0, v56
    v_mfma_f32_16x16x32_bf16 v[92:95], v[140:143], v[116:119], v[92:95]
    v_max_f32 v57, 0, v57
    v_max_f32 v58, 0, v58
    v_max_f32 v59, 0, v59
    v_pk_mul_f32 v[48:49], v[48:49], v[52:53]
    v_pk_mul_f32 v[50:51], v[50:51], v[54:55]
    v_pk_mul_f32 v[56:57], v[56:57], v[60:61]
    v_pk_mul_f32 v[58:59], v[58:59], v[62:63]
    v_cvt_pk_bf16_f32 v48, v48, v49
    v_cvt_pk_bf16_f32 v49, v50, v51
    v_cvt_pk_bf16_f32 v50, v56, v57
    v_cvt_pk_bf16_f32 v51, v58, v59
    buffer_store_dwordx4 v[48:51], v30, s[52:55], s84 offen sc1
    s_add_u32 s84, s84, 57344
    v_pk_fma_f32 v[64:65], v[192:193], v[18:19], v[64:65] op_sel:[0,0,0] op_sel_hi:[1,0,1] neg_lo:[0,1,0] neg_hi:[0,1,0]
    v_pk_fma_f32 v[66:67], v[194:195], v[18:19], v[66:67] op_sel:[0,0,0] op_sel_hi:[1,0,1] neg_lo:[0,1,0] neg_hi:[0,1,0]
    v_pk_fma_f32 v[68:69], v[196:197], v[18:19], v[68:69] op_sel:[0,0,0] op_sel_hi:[1,0,1] neg_lo:[0,1,0] neg_hi:[0,1,0]
    v_pk_fma_f32 v[70:71], v[198:199], v[18:19], v[70:71] op_sel:[0,0,0] op_sel_hi:[1,0,1] neg_lo:[0,1,0] neg_hi:[0,1,0]
    v_pk_fma_f32 v[72:73], v[200:201], v[18:19], v[72:73] op_sel:[0,0,0] op_sel_hi:[1,0,1] neg_lo:[0,1,0] neg_hi:[0,1,0]
    v_pk_fma_f32 v[74:75], v[202:203], v[18:19], v[74:75] op_sel:[0,0,0] op_sel_hi:[1,0,1] neg_lo:[0,1,0] neg_hi:[0,1,0]
    v_pk_fma_f32 v[76:77], v[204:205], v[18:19], v[76:77] op_sel:[0,0,0] op_sel_hi:[1,0,1] neg_lo:[0,1,0] neg_hi:[0,1,0]
    v_pk_fma_f32 v[78:79], v[206:207], v[18:19], v[78:79] op_sel:[0,0,0] op_sel_hi:[1,0,1] neg_lo:[0,1,0] neg_hi:[0,1,0]
    v_max_f32 v64, 0, v64
    v_max_f32 v65, 0, v65
    v_max_f32 v66, 0, v66
    v_max_f32 v67, 0, v67
    v_max_f32 v72, 0, v72
    v_max_f32 v73, 0, v73
    v_max_f32 v74, 0, v74
    v_max_f32 v75, 0, v75
    v_pk_mul_f32 v[64:65], v[64:65], v[68:69]
    v_pk_mul_f32 v[66:67], v[66:67], v[70:71]
    v_pk_mul_f32 v[72:73], v[72:73], v[76:77]
    v_pk_mul_f32 v[74:75], v[74:75], v[78:79]
    v_cvt_pk_bf16_f32 v64, v64, v65
    v_cvt_pk_bf16_f32 v65, v66, v67
    v_cvt_pk_bf16_f32 v66, v72, v73
    v_cvt_pk_bf16_f32 v67, v74, v75
    buffer_store_dwordx4 v[64:67], v30, s[52:55], s84 offen sc1
    s_add_u32 s84, s84, 57344
    v_pk_fma_f32 v[80:81], v[192:193], v[18:19], v[80:81] op_sel:[0,1,0] op_sel_hi:[1,1,1] neg_lo:[0,1,0] neg_hi:[0,1,0]
    v_pk_fma_f32 v[82:83], v[194:195], v[18:19], v[82:83] op_sel:[0,1,0] op_sel_hi:[1,1,1] neg_lo:[0,1,0] neg_hi:[0,1,0]
    v_pk_fma_f32 v[84:85], v[196:197], v[18:19], v[84:85] op_sel:[0,1,0] op_sel_hi:[1,1,1] neg_lo:[0,1,0] neg_hi:[0,1,0]
    v_pk_fma_f32 v[86:87], v[198:199], v[18:19], v[86:87] op_sel:[0,1,0] op_sel_hi:[1,1,1] neg_lo:[0,1,0] neg_hi:[0,1,0]
    v_pk_fma_f32 v[88:89], v[200:201], v[18:19], v[88:89] op_sel:[0,1,0] op_sel_hi:[1,1,1] neg_lo:[0,1,0] neg_hi:[0,1,0]
    v_pk_fma_f32 v[90:91], v[202:203], v[18:19], v[90:91] op_sel:[0,1,0] op_sel_hi:[1,1,1] neg_lo:[0,1,0] neg_hi:[0,1,0]
    v_pk_fma_f32 v[92:93], v[204:205], v[18:19], v[92:93] op_sel:[0,1,0] op_sel_hi:[1,1,1] neg_lo:[0,1,0] neg_hi:[0,1,0]
    v_pk_fma_f32 v[94:95], v[206:207], v[18:19], v[94:95] op_sel:[0,1,0] op_sel_hi:[1,1,1] neg_lo:[0,1,0] neg_hi:[0,1,0]
    v_max_f32 v80, 0, v80
    v_max_f32 v81, 0, v81
    v_max_f32 v82, 0, v82
    v_max_f32 v83, 0, v83
    v_max_f32 v88, 0, v88
    v_max_f32 v89, 0, v89
    v_max_f32 v90, 0, v90
    v_max_f32 v91, 0, v91
    v_pk_mul_f32 v[80:81], v[80:81], v[84:85]
    v_pk_mul_f32 v[82:83], v[82:83], v[86:87]
    v_pk_mul_f32 v[88:89], v[88:89], v[92:93]
    v_pk_mul_f32 v[90:91], v[90:91], v[94:95]
    v_cvt_pk_bf16_f32 v80, v80, v81
    v_cvt_pk_bf16_f32 v81, v82, v83
    v_cvt_pk_bf16_f32 v82, v88, v89
    v_cvt_pk_bf16_f32 v83, v90, v91
    buffer_store_dwordx4 v[80:83], v30, s[52:55], s84 offen sc1
    s_add_u32 s84, s84, 57344
    ds_write_addtid_b32 v239 offset:864
    ds_write_addtid_b32 v240 offset:1152
    ds_write_addtid_b32 v241 offset:1440
    ds_write_addtid_b32 v242 offset:1728
    ds_write_addtid_b32 v242 offset:2016
    ds_write_addtid_b32 v243 offset:2304
    ds_write_addtid_b32 v244 offset:2592
    ds_write_addtid_b32 v245 offset:2880
    ds_write_addtid_b32 v246 offset:3168
    ds_write_addtid_b32 v247 offset:3456
    ds_write_addtid_b32 v248 offset:3744
    ds_write_addtid_b32 v249 offset:4032
    ds_write_addtid_b32 v250 offset:4320
    s_lshl_b32 s64, s93, 8
    s_mul_i32 s65, s86, 16704
    s_add_u32 s65, s65, s64
    s_add_u32 s65, s65, 123904
    v_add_u32 v1, s65, v218
    s_mul_i32 s65, s86, 4608
    s_add_u32 s65, s65, s64
    s_add_u32 s65, s65, 115168
    v_add_u32 v2, s65, v219
    s_waitcnt vmcnt(10)
    ds_write_b128 v31, v[8:11]
    s_waitcnt vmcnt(9)
    v_mov_b32_dpp v26, v8 row_shl:2 row_mask:0xf bank_mask:0xf
    v_mov_b32_dpp v27, v9 row_shl:2 row_mask:0xf bank_mask:0xf
    v_alignbit_b32 v220, v9, v8, 16
    v_alignbit_b32 v221, v10, v9, 16
    v_alignbit_b32 v222, v11, v10, 16
    v_alignbit_b32 v223, v26, v11, 16
    ds_write_b128 v31, v[220:223] offset:4160
    v_mov_b32 v220, v9
    v_mov_b32 v221, v10
    v_mov_b32 v222, v11
    v_mov_b32 v223, v26
    ds_write_b128 v31, v[220:223] offset:8320
    v_alignbit_b32 v220, v10, v9, 16
    v_alignbit_b32 v221, v11, v10, 16
    v_alignbit_b32 v222, v26, v11, 16
    v_alignbit_b32 v223, v27, v26, 16
    ds_write_b128 v31, v[220:223] offset:12480
    s_cmp_lg_u32 s60, 0
    s_cbranch_scc1 L_w0_16
    v_lshlrev_b32 v220, 16, v8
    v_alignbit_b32 v221, v9, v8, 16
    s_mov_b64 exec, 3
    ds_write_b32 v31, v220 offset:4156
    ds_write_b32 v31, v8 offset:8316
    ds_write_b32 v31, v220 offset:12472
    ds_write_b32 v31, v221 offset:12476
    s_mov_b64 exec, -1
L_w0_16:
    s_waitcnt lgkmcnt(0)
    s_barrier
    ds_read_b128 v[224:227], v208 offset:0
    ds_read_b128 v[228:231], v210 offset:0
    ds_read_b128 v[232:235], v208 offset:64
    ds_read_b128 v[236:239], v210 offset:64
    ds_read_b128 v[240:243], v208 offset:128
    ds_read_b128 v[244:247], v210 offset:128
    ds_read_b128 v[248:251], v208 offset:192
    ds_read_b128 v[252:255], v210 offset:192
    s_waitcnt lgkmcnt(6)
    v_mfma_f32_16x16x32_bf16 v[112:115], v[224:227], v[228:231], 0
    ds_read_b128 v[224:227], v209 offset:0
    ds_read_b128 v[228:231], v211 offset:0
    s_waitcnt lgkmcnt(6)
    v_mfma_f32_16x16x32_bf16 v[112:115], v[232:235], v[236:239], v[112:115]
    ds_read_b128 v[232:235], v209 offset:64
    ds_read_b128 v[236:239], v211 offset:64
    s_waitcnt lgkmcnt(6)
    v_mfma_f32_16x16x32_bf16 v[112:115], v[240:243], v[244:247], v[112:115]
    ds_read_b128 v[240:243], v209 offset:128
    ds_read_b128 v[244:247], v211 offset:128
    s_waitcnt lgkmcnt(6)
    v_mfma_f32_16x16x32_bf16 v[112:115], v[248:251], v[252:255], v[112:115]
    ds_read_b128 v[248:251], v209 offset:192
    ds_read_b128 v[252:255], v211 offset:192
    s_waitcnt lgkmcnt(6)
    v_mfma_f32_16x16x32_bf16 v[112:115], v[224:227], v[228:231], v[112:115]
    s_waitcnt lgkmcnt(4)
    v_mfma_f32_16x16x32_bf16 v[112:115], v[232:235], v[236:239], v[112:115]
    s_waitcnt lgkmcnt(2)
    v_mfma_f32_16x16x32_bf16 v[112:115], v[240:243], v[244:247], v[112:115]
    s_waitcnt lgkmcnt(0)
    v_mfma_f32_16x16x32_bf16 v[112:115], v[248:251], v[252:255], v[112:115]
    s_waitcnt vmcnt(0)
    s_mov_b64 exec, 255
    buffer_store_dwordx4 v[20:23], v30, s[52:55], s83 offen sc1
    s_mov_b64 exec, -1
    s_add_u32 s79, s78, s9
    buffer_load_dwordx4 v[192:195], v30, s[52:55], s79 offen offset:0 sc1
    buffer_load_dwordx4 v[196:199], v30, s[52:55], s79 offen offset:1024 sc1
    buffer_load_dwordx4 v[200:203], v30, s[52:55], s79 offen offset:2048 sc1
    buffer_load_dwordx4 v[204:207], v30, s[52:55], s79 offen offset:3072 sc1
    s_add_u32 s9, s9, 4096
    s_cmp_eq_u32 s9, 28672
    s_cmov_b32 s9, 0
    v_cvt_pk_bf16_f32 v116, v115, v114
    v_cvt_pk_bf16_f32 v117, v113, v112
    ds_write_b64 v212, v[116:117]
    s_setprio 0
    s_branch L_post
L_gv:
    s_setprio 1
    s_waitcnt vmcnt(8)
    s_barrier
    ds_read_b64_tr_b16 v[96:97], v1 offset:0
    ds_read_b64_tr_b16 v[98:99], v1 offset:1024
    ds_read_b128 v[112:115], v3 offset:0
    ds_read_b128 v[116:119], v3 offset:2048
    ds_read_b128 v[120:123], v3 offset:4096
    ds_read_b128 v[124:127], v3 offset:6144
    ds_read_b64_tr_b16 v[100:101], v1 offset:8192
    ds_read_b64_tr_b16 v[102:103], v1 offset:9216
    ds_read_b64_tr_b16 v[104:105], v2 offset:0
    ds_read_b64_tr_b16 v[106:107], v2 offset:1024
    ds_read_b64_tr_b16 v[108:109], v2 offset:8192
    ds_read_b64_tr_b16 v[110:111], v2 offset:9216
    s_waitcnt lgkmcnt(9)
    v_mfma_f32_16x16x32_bf16 v[32:35], v[96:99], v[112:115], 0
    s_add_u32 m0, s74, 49152
    s_nop 0
    buffer_load_dwordx4 v7, s[40:43], s72 offen lds
    s_lshl_b32 s64, s71, 2
    s_waitcnt lgkmcnt(8)
    v_mfma_f32_16x16x32_bf16 v[48:51], v[96:99], v[116:119], 0
    buffer_load_dwordx4 v8, s[40:43], s72 offen offset:1024 lds
    s_add_u32 s72, s72, 114688
    s_cmp_eq_u32 s72, 1835008
    s_cmov_b32 s72, 0
    s_lshr_b32 s65, s60, 1
    s_waitcnt lgkmcnt(7)
    v_mfma_f32_16x16x32_bf16 v[64:67], v[96:99], v[120:123], 0
    s_cmp_lg_u32 s59, 0
    s_cbranch_scc1 L_cs_26
    v_mfma_f32_16x16x32_bf16 v[144:147], v[148:151], v[96:99], 0
    s_waitcnt lgkmcnt(2)
    v_mfma_f32_16x16x32_bf16 v[144:147], v[152:155], v[104:107], v[144:147]
L_cs_26:
    s_cmp_lg_u32 s59, 1
    s_cbranch_scc1 L_cs_27
    s_waitcnt lgkmcnt(4)
    s_nop 4
    v_mfma_f32_16x16x32_bf16 v[144:147], v[148:151], v[100:103], 0
    s_waitcnt lgkmcnt(0)
    v_mfma_f32_16x16x32_bf16 v[144:147], v[152:155], v[108:111], v[144:147]
L_cs_27:
    s_add_u32 s64, s64, s65
    s_waitcnt lgkmcnt(6)
    v_mfma_f32_16x16x32_bf16 v[80:83], v[96:99], v[124:127], 0
    s_waitcnt vmcnt(8) lgkmcnt(0)
    s_barrier
    ds_read_b64_tr_b16 v[96:97], v1 offset:16384
    ds_read_b64_tr_b16 v[98:99], v1 offset:17408
    s_lshl_b32 s64, s64, 4
    v_mfma_f32_16x16x32_bf16 v[36:39], v[100:103], v[112:115], 0
    ds_read_b128 v[140:143], v4 offset:6144
    s_add_u32 s64, s64, s70
    v_mfma_f32_16x16x32_bf16 v[52:55], v[100:103], v[116:119], 0
    ds_read_b128 v[136:139], v4 offset:4096
    s_add_u32 m0, s74, 0
    s_nop 0
    buffer_load_dwordx4 v7, s[40:43], s72 offen lds
    s_lshl_b32 s64, s64, 1
    v_mfma_f32_16x16x32_bf16 v[68:71], v[100:103], v[120:123], 0
    ds_read_b128 v[132:135], v4 offset:2048
    s_add_u32 s64, s64, s86
    v_mfma_f32_16x16x32_bf16 v[84:87], v[100:103], v[124:127], 0
    ds_read_b64_tr_b16 v[100:101], v1 offset:24576
    ds_read_b64_tr_b16 v[102:103], v1 offset:25600
    s_lshl_b32 s64, s64, 8
    v_mfma_f32_16x16x32_bf16 v[40:43], v[104:107], v[112:115], 0
    ds_read_b128 v[128:131], v4 offset:0
    buffer_load_dwordx4 v8, s[40:43], s72 offen offset:1024 lds
    s_add_u32 s72, s72, 114688
    s_cmp_eq_u32 s72, 1835008
    s_cmov_b32 s72, 0
    s_add_u32 s82, s64, 14680064
    v_mfma_f32_16x16x32_bf16 v[56:59], v[104:107], v[116:119], 0
    s_mul_i32 s64, s60, 7
    s_lshr_b32 s65, s64, 1
    v_mfma_f32_16x16x32_bf16 v[72:75], v[104:107], v[120:123], 0
    s_mul_i32 s66, s76, 28
    s_add_u32 s65, s65, s66
    v_mfma_f32_16x16x32_bf16 v[88:91], v[104:107], v[124:127], 0
    ds_read_b64_tr_b16 v[104:105], v2 offset:16384
    ds_read_b64_tr_b16 v[106:107], v2 offset:17408
    v_min_u32 v28, 3, v0
    v_mfma_f32_16x16x32_bf16 v[44:47], v[108:111], v[112:115], 0
    v_add_u32 v28, s65, v28
    v_lshlrev_b32 v28, 7, v28
    v_mfma_f32_16x16x32_bf16 v[60:63], v[108:111], v[116:119], 0
    s_add_u32 m0, s74, 98304
    s_nop 0
    buffer_load_dwordx4 v9, s[36:39], s73 offen lds
    v_add_u32 v28, 32768, v28
    v_mfma_f32_16x16x32_bf16 v[76:79], v[108:111], v[120:123], 0
    s_mul_i32 s65, s76, 56
    s_add_u32 s64, s64, s65
    v_mfma_f32_16x16x32_bf16 v[92:95], v[108:111], v[124:127], 0
    ds_read_b64_tr_b16 v[108:109], v2 offset:24576
    ds_read_b64_tr_b16 v[110:111], v2 offset:25600
    buffer_load_dwordx4 v10, s[36:39], s73 offen offset:1024 lds
    s_add_u32 s73, s73, 128
    s_and_b32 s73, s73, 0x3ff
    s_lshl_b32 s64, s64, 12
    s_waitcnt lgkmcnt(4)
    v_mfma_f32_16x16x32_bf16 v[32:35], v[96:99], v[128:131], v[32:35]
    s_add_u32 s78, s64, 12845056
    s_and_b32 s64, s75, 3
    v_mfma_f32_16x16x32_bf16 v[48:51], v[96:99], v[132:135], v[48:51]
    s_mov_b32 m0, s94
    s_nop 0
    buffer_load_dwordx4 v29, s[44:47], s85 offen lds
    s_lshl_b32 s64, s64, 2
    v_mfma_f32_16x16x32_bf16 v[64:67], v[96:99], v[136:139], v[64:67]
    s_cmp_lg_u32 s59, 2
    s_cbranch_scc1 L_cs_28
    v_mfma_f32_16x16x32_bf16 v[144:147], v[148:151], v[96:99], 0
    s_waitcnt lgkmcnt(2)
    v_mfma_f32_16x16x32_bf16 v[144:147], v[152:155], v[104:107], v[144:147]
L_cs_28:
    s_cmp_lg_u32 s59, 3
    s_cbranch_scc1 L_cs_29
    s_nop 5
    v_mfma_f32_16x16x32_bf16 v[144:147], v[148:151], v[100:103], 0
    s_waitcnt lgkmcnt(0)
    v_mfma_f32_16x16x32_bf16 v[144:147], v[152:155], v[108:111], v[144:147]
L_cs_29:
    s_lshr_b32 s64, 0x4040, s64
    v_mfma_f32_16x16x32_bf16 v[80:83], v[96:99], v[140:143], v[80:83]
    s_waitcnt vmcnt(9) lgkmcnt(0)
    s_barrier
    ds_read_b64_tr_b16 v[96:97], v1 offset:32768
    ds_read_b64_tr_b16 v[98:99], v1 offset:33792
    s_and_b32 s64, s64, 7
    v_mfma_f32_16x16x32_bf16 v[36:39], v[100:103], v[128:131], v[36:39]
    ds_read_b128 v[124:127], v3 offset:22528
    s_lshl_b32 s9, s64, 12
    v_mfma_f32_16x16x32_bf16 v[52:55], v[100:103], v[132:135], v[52:55]
    ds_read_b128 v[120:123], v3 offset:20480
    s_add_u32 m0, s74, 16384
    s_nop 0
    buffer_load_dwordx4 v7, s[40:43], s72 offen lds
    v_lshrrev_b32 v24, 4, v0
    v_mfma_f32_16x16x32_bf16 v[68:71], v[100:103], v[136:139], v[68:71]
    ds_read_b128 v[116:119], v3 offset:18432
    v_and_b32 v25, 0xf0, v30
    v_mfma_f32_16x16x32_bf16 v[84:87], v[100:103], v[140:143], v[84:87]
    ds_read_b64_tr_b16 v[100:101], v1 offset:40960
    ds_read_b64_tr_b16 v[102:103], v1 offset:41984
    v_lshl_add_u32 v12, v24, 16, v25
    v_mfma_f32_16x16x32_bf16 v[40:43], v[104:107], v[128:131], v[40:43]
    ds_read_b128 v[112:115], v3 offset:16384
    buffer_load_dwordx4 v8, s[40:43], s72 offen offset:1024 lds
    s_add_u32 s72, s72, 114688
    s_cmp_eq_u32 s72, 1835008
    s_cmov_b32 s72, 0
    v_lshrrev_b32 v24, 1, v0
    v_mfma_f32_16x16x32_bf16 v[56:59], v[104:107], v[132:135], v[56:59]
    v_and_b32 v25, 1, v0
    s_lshl_b32 s64, s60, 18
    v_mfma_f32_16x16x32_bf16 v[72:75], v[104:107], v[136:139], v[72:75]
    s_lshl_b32 s65, s58, 8
    s_add_u32 s64, s64, s65
    v_mfma_f32_16x16x32_bf16 v[88:91], v[104:107], v[140:143], v[88:91]
    ds_read_b64_tr_b16 v[104:105], v2 offset:32768
    ds_read_b64_tr_b16 v[106:107], v2 offset:33792
    s_add_u32 s89, s64, 1048576
    v_mfma_f32_16x16x32_bf16 v[44:47], v[108:111], v[128:131], v[44:47]
    v_mul_u32_u24 v25, 16704, v25
    v_lshl_add_u32 v24, v24, 4, v25
    v_mfma_f32_16x16x32_bf16 v[60:63], v[108:111], v[132:135], v[60:63]
    s_add_u32 m0, s74, 65536
    s_nop 0
    buffer_load_dwordx4 v9, s[36:39], s73 offen lds
    s_lshl_b32 s64, s60, 9
    v_mfma_f32_16x16x32_bf16 v[76:79], v[108:111], v[136:139], v[76:79]
    s_add_u32 s64, s64, 123936
    v_add_u32 v31, s64, v24
    v_mfma_f32_16x16x32_bf16 v[92:95], v[108:111], v[140:143], v[92:95]
    ds_read_b64_tr_b16 v[108:109], v2 offset:40960
    ds_read_b64_tr_b16 v[110:111], v2 offset:41984
    s_lshl_b32 s64, s70, 1
    s_waitcnt lgkmcnt(4)
    v_mfma_f32_16x16x32_bf16 v[32:35], v[96:99], v[112:115], v[32:35]
    buffer_load_dwordx4 v10, s[36:39], s73 offen offset:1024 lds
    s_add_u32 s73, s73, 128
    s_and_b32 s73, s73, 0x3ff
    s_add_u32 s64, s64, s86
    v_mfma_f32_16x16x32_bf16 v[48:51], v[96:99], v[116:119], v[48:51]
    s_lshl_b32 s91, s64, 8
    s_add_u32 s91, s91, 65536
    v_mfma_f32_16x16x32_bf16 v[64:67], v[96:99], v[120:123], v[64:67]
    s_mul_i32 s64, s64, 224
    s_lshl_b32 s65, s71, 2
    v_mfma_f32_16x16x32_bf16 v[80:83], v[96:99], v[124:127], v[80:83]
    s_waitcnt vmcnt(4) lgkmcnt(0)
    s_barrier
    ds_read_b64_tr_b16 v[96:97], v1 offset:49152
    ds_read_b64_tr_b16 v[98:99], v1 offset:50176
    s_lshr_b32 s66, s60, 1
    v_mfma_f32_16x16x32_bf16 v[36:39], v[100:103], v[112:115], v[36:39]
    ds_read_b128 v[140:143], v4 offset:22528
    s_add_u32 s66, s66, s65
    v_mfma_f32_16x16x32_bf16 v[52:55], v[100:103], v[116:119], v[52:55]
    ds_read_b128 v[136:139], v4 offset:20480
    ds_read_b64_tr_b16 v[156:157], v160
    s_add_u32 s65, s66, s64
    v_mfma_f32_16x16x32_bf16 v[68:71], v[100:103], v[120:123], v[68:71]
    ds_read_b128 v[132:135], v4 offset:18432
    ds_read_b64_tr_b16 v[158:159], v160 offset:2048
    s_lshl_b32 s65, s65, 10
    v_mfma_f32_16x16x32_bf16 v[84:87], v[100:103], v[124:127], v[84:87]
    ds_read_b64_tr_b16 v[100:101], v1 offset:57344
    ds_read_b64_tr_b16 v[102:103], v1 offset:58368
    v_mov_b32 v147, s63
    s_mov_b64 exec, 0xffff
    buffer_store_dwordx4 v[144:147], v30, s[52:55], s82 offen sc1
    s_mov_b64 exec, -1
    s_add_u32 s84, s65, 5505024
    v_mfma_f32_16x16x32_bf16 v[40:43], v[104:107], v[112:115], v[40:43]
    ds_read_b128 v[128:131], v4 offset:16384
    s_add_u32 m0, s74, 32768
    s_nop 0
    buffer_load_dwordx4 v7, s[40:43], s72 offen lds
    s_mul_i32 s64, s70, 14
    v_mfma_f32_16x16x32_bf16 v[56:59], v[104:107], v[116:119], v[56:59]
    buffer_load_dwordx4 v8, s[40:43], s72 offen offset:1024 lds
    s_add_u32 s72, s72, 114688
    s_cmp_eq_u32 s72, 1835008
    s_cmov_b32 s72, 0
    s_add_u32 s64, s64, s71
    v_mfma_f32_16x16x32_bf16 v[72:75], v[104:107], v[120:123], v[72:75]
    s_lshl_b32 s64, s64, 3
    s_add_u32 s64, s64, s60
    v_mfma_f32_16x16x32_bf16 v[88:91], v[104:107], v[124:127], v[88:91]
    ds_read_b64_tr_b16 v[104:105], v2 offset:49152
    ds_read_b64_tr_b16 v[106:107], v2 offset:50176
    s_lshl_b32 s64, s64, 7
    v_mfma_f32_16x16x32_bf16 v[44:47], v[108:111], v[112:115], v[44:47]
    s_add_u32 s83, s64, 229376
    s_lshl_b32 s65, s66, 9
    v_mfma_f32_16x16x32_bf16 v[60:63], v[108:111], v[116:119], v[60:63]
    s_waitcnt lgkmcnt(5)
    buffer_store_dwordx4 v[156:159], v30, s[52:55], s79 offen sc1
    s_add_u32 s90, s65, 196608
    v_mfma_f32_16x16x32_bf16 v[76:79], v[108:111], v[120:123], v[76:79]
    v_lshlrev_b32 v14, 3, v0
    v_and_b32 v6, 0xf0, v30
    v_mfma_f32_16x16x32_bf16 v[92:95], v[108:111], v[124:127], v[92:95]
    ds_read_b64_tr_b16 v[108:109], v2 offset:57344
    ds_read_b64_tr_b16 v[110:111], v2 offset:58368
    s_lshl_b32 s64, s60, 8
    s_waitcnt lgkmcnt(4)
    v_mfma_f32_16x16x32_bf16 v[32:35], v[96:99], v[128:131], v[32:35]
    s_add_u32 s92, s64, 114688
    v_lshrrev_b32 v5, 4, v0
    v_mfma_f32_16x16x32_bf16 v[48:51], v[96:99], v[132:135], v[48:51]
    v_lshl_add_u32 v5, v5, 4, s92
    v_mov_b32 v210, s56
    v_mfma_f32_16x16x32_bf16 v[64:67], v[96:99], v[136:139], v[64:67]
    s_mov_b32 s3, 0x3fb8aa3b
    v_mul_f32 v218, s3, v210
    v_mfma_f32_16x16x32_bf16 v[80:83], v[96:99], v[140:143], v[80:83]
    s_waitcnt lgkmcnt(0)
    s_barrier
    ds_read_b64_tr_b16 v[96:97], v1 offset:0
    ds_read_b64_tr_b16 v[98:99], v1 offset:1024
    v_fma_f32 v219, v210, s3, -v218
    v_mfma_f32_16x16x32_bf16 v[36:39], v[100:103], v[128:131], v[36:39]
    ds_read_b128 v[124:127], v3 offset:38912
    v_fmamk_f32 v219, v210, 0x32a57060, v219
    v_mfma_f32_16x16x32_bf16 v[52:55], v[100:103], v[132:135], v[52:55]
    ds_read_b128 v[120:123], v3 offset:36864
    s_add_u32 m0, s74, 49152
    s_nop 0
    buffer_load_dwordx4 v7, s[40:43], s72 offen lds
    v_exp_f32 v218, v218
    v_mfma_f32_16x16x32_bf16 v[68:71], v[100:103], v[136:139], v[68:71]
    ds_read_b128 v[116:119], v3 offset:34816
    v_mul_f32 v219, 0x3f317218, v219
    v_mfma_f32_16x16x32_bf16 v[84:87], v[100:103], v[140:143], v[84:87]
    ds_read_b64_tr_b16 v[100:101], v1 offset:8192
    ds_read_b64_tr_b16 v[102:103], v1 offset:9216
    v_fma_f32 v218, v218, v219, v218
    v_mfma_f32_16x16x32_bf16 v[40:43], v[104:107], v[128:131], v[40:43]
    ds_read_b128 v[112:115], v3 offset:32768
    buffer_load_dwordx4 v8, s[40:43], s72 offen offset:1024 lds
    s_add_u32 s72, s72, 114688
    s_cmp_eq_u32 s72, 1835008
    s_cmov_b32 s72, 0
    v_cvt_pk_bf16_f32 v218, v218, v218
    v_mfma_f32_16x16x32_bf16 v[56:59], v[104:107], v[132:135], v[56:59]
    v_and_b32 v218, s88, v218
    v_lshlrev_b32 v212, 16, v212
    v_mfma_f32_16x16x32_bf16 v[72:75], v[104:107], v[136:139], v[72:75]
    v_lshlrev_b32 v213, 16, v213
    v_mul_f32 v212, v218, v212
    v_mfma_f32_16x16x32_bf16 v[88:91], v[104:107], v[140:143], v[88:91]
    ds_read_b64_tr_b16 v[104:105], v2 offset:0
    ds_read_b64_tr_b16 v[106:107], v2 offset:1024
    v_mul_f32 v213, v218, v213
    v_mfma_f32_16x16x32_bf16 v[44:47], v[108:111], v[128:131], v[44:47]
    v_mul_f32 v212, s3, v212
    v_mul_f32 v213, 0x3e22f983, v213
    v_mfma_f32_16x16x32_bf16 v[60:63], v[108:111], v[132:135], v[60:63]
    s_add_u32 m0, s74, 81920
    s_nop 0
    buffer_load_dwordx4 v9, s[36:39], s73 offen lds
    v_mul_f32 v210, 0x41000000, v212
    v_mfma_f32_16x16x32_bf16 v[76:79], v[108:111], v[136:139], v[76:79]
    v_mul_f32 v211, 0x41000000, v213
    v_exp_f32 v210, v210
    v_mfma_f32_16x16x32_bf16 v[92:95], v[108:111], v[140:143], v[92:95]
    ds_read_b64_tr_b16 v[108:109], v2 offset:8192
    ds_read_b64_tr_b16 v[110:111], v2 offset:9216
    v_fract_f32 v211, v211
    s_waitcnt lgkmcnt(4)
    v_mfma_f32_16x16x32_bf16 v[32:35], v[96:99], v[112:115], v[32:35]
    buffer_load_dwordx4 v10, s[36:39], s73 offen offset:1024 lds
    s_add_u32 s73, s73, 128
    s_and_b32 s73, s73, 0x3ff
    v_cos_f32 v198, v211
    v_mfma_f32_16x16x32_bf16 v[48:51], v[96:99], v[116:119], v[48:51]
    v_sin_f32 v199, v211
    v_mul_f32 v198, v210, v198
    v_mfma_f32_16x16x32_bf16 v[64:67], v[96:99], v[120:123], v[64:67]
    v_mul_f32 v199, v210, v199
    v_mul_f32 v210, 0x43000000, v212
    v_mfma_f32_16x16x32_bf16 v[80:83], v[96:99], v[124:127], v[80:83]
    s_waitcnt vmcnt(10) lgkmcnt(0)
    s_barrier
    ds_read_b64_tr_b16 v[96:97], v1 offset:16384
    ds_read_b64_tr_b16 v[98:99], v1 offset:17408
    v_mul_f32 v211, 0x43000000, v213
    v_mfma_f32_16x16x32_bf16 v[36:39], v[100:103], v[112:115], v[36:39]
    ds_read_b128 v[140:143], v4 offset:38912
    v_exp_f32 v210, v210
    v_mfma_f32_16x16x32_bf16 v[52:55], v[100:103], v[116:119], v[52:55]
    ds_read_b128 v[136:139], v4 offset:36864
    s_add_u32 m0, s74, 0
    s_nop 0
    buffer_load_dwordx4 v7, s[40:43], s72 offen lds
    v_fract_f32 v211, v211
    v_mfma_f32_16x16x32_bf16 v[68:71], v[100:103], v[120:123], v[68:71]
    ds_read_b128 v[132:135], v4 offset:34816
    v_cos_f32 v194, v211
    v_mfma_f32_16x16x32_bf16 v[84:87], v[100:103], v[124:127], v[84:87]
    ds_read_b64_tr_b16 v[100:101], v1 offset:24576
    ds_read_b64_tr_b16 v[102:103], v1 offset:25600
    v_sin_f32 v195, v211
    v_mfma_f32_16x16x32_bf16 v[40:43], v[104:107], v[112:115], v[40:43]
    ds_read_b128 v[128:131], v4 offset:32768
    buffer_load_dwordx4 v8, s[40:43], s72 offen offset:1024 lds
    s_add_u32 s72, s72, 114688
    s_cmp_eq_u32 s72, 1835008
    s_cmov_b32 s72, 0
    v_mul_f32 v194, v210, v194
    v_mfma_f32_16x16x32_bf16 v[56:59], v[104:107], v[116:119], v[56:59]
    v_mul_f32 v195, v210, v195
    v_mov_b32 v206, 1.0
    v_mfma_f32_16x16x32_bf16 v[72:75], v[104:107], v[120:123], v[72:75]
    v_mov_b32 v207, 0
    v_cvt_pk_bf16_f32 v224, v206, v207
    v_mfma_f32_16x16x32_bf16 v[88:91], v[104:107], v[124:127], v[88:91]
    ds_read_b64_tr_b16 v[104:105], v2 offset:16384
    ds_read_b64_tr_b16 v[106:107], v2 offset:17408
    v_cvt_pk_bf16_f32 v225, v194, v195
    v_mfma_f32_16x16x32_bf16 v[44:47], v[108:111], v[112:115], v[44:47]
    v_mul_f32 v208, v206, v198
    v_mul_f32 v209, v206, v199
    v_mfma_f32_16x16x32_bf16 v[60:63], v[108:111], v[116:119], v[60:63]
    v_fma_f32 v208, -v207, v199, v208
    v_fmac_f32 v209, v207, v198
    v_mfma_f32_16x16x32_bf16 v[76:79], v[108:111], v[120:123], v[76:79]
    v_mul_f32 v196, v194, v198
    v_mul_f32 v197, v194, v199
    v_mfma_f32_16x16x32_bf16 v[92:95], v[108:111], v[124:127], v[92:95]
    ds_read_b64_tr_b16 v[108:109], v2 offset:24576
    ds_read_b64_tr_b16 v[110:111], v2 offset:25600
    v_fma_f32 v196, -v195, v199, v196
    s_waitcnt lgkmcnt(4)
    v_mfma_f32_16x16x32_bf16 v[32:35], v[96:99], v[128:131], v[32:35]
    v_fmac_f32 v197, v195, v198
    v_cvt_pk_bf16_f32 v226, v208, v209
    v_mfma_f32_16x16x32_bf16 v[48:51], v[96:99], v[132:135], v[48:51]
    v_cvt_pk_bf16_f32 v227, v196, v197
    v_mul_f32 v206, v208, v198
    v_mfma_f32_16x16x32_bf16 v[64:67], v[96:99], v[136:139], v[64:67]
    v_mul_f32 v207, v208, v199
    v_fma_f32 v206, -v209, v199, v206
    v_mfma_f32_16x16x32_bf16 v[80:83], v[96:99], v[140:143], v[80:83]
    s_waitcnt vmcnt(6) lgkmcnt(0)
    s_barrier
    ds_read_b64_tr_b16 v[96:97], v1 offset:32768
    ds_read_b64_tr_b16 v[98:99], v1 offset:33792
    v_fmac_f32 v207, v209, v198
    v_mfma_f32_16x16x32_bf16 v[36:39], v[100:103], v[128:131], v[36:39]
    ds_read_b128 v[124:127], v3 offset:6144
    v_mul_f32 v194, v196, v198
    v_mfma_f32_16x16x32_bf16 v[52:55], v[100:103], v[132:135], v[52:55]
    ds_read_b128 v[120:123], v3 offset:4096
    s_add_u32 m0, s74, 16384
    s_nop 0
    buffer_load_dwordx4 v7, s[40:43], s72 offen lds
    v_mul_f32 v195, v196, v199
    v_mfma_f32_16x16x32_bf16 v[68:71], v[100:103], v[136:139], v[68:71]
    ds_read_b128 v[116:119], v3 offset:2048
    v_fma_f32 v194, -v197, v199, v194
    v_mfma_f32_16x16x32_bf16 v[84:87], v[100:103], v[140:143], v[84:87]
    ds_read_b64_tr_b16 v[100:101], v1 offset:40960
    ds_read_b64_tr_b16 v[102:103], v1 offset:41984
    v_fmac_f32 v195, v197, v198
    v_mfma_f32_16x16x32_bf16 v[40:43], v[104:107], v[128:131], v[40:43]
    ds_read_b128 v[112:115], v3 offset:0
    buffer_load_dwordx4 v8, s[40:43], s72 offen offset:1024 lds
    s_add_u32 s72, s72, 114688
    s_cmp_eq_u32 s72, 1835008
    s_cmov_b32 s72, 0
    v_cvt_pk_bf16_f32 v228, v206, v207
    v_mfma_f32_16x16x32_bf16 v[56:59], v[104:107], v[132:135], v[56:59]
    v_cvt_pk_bf16_f32 v229, v194, v195
    v_mul_f32 v208, v206, v198
    v_mfma_f32_16x16x32_bf16 v[72:75], v[104:107], v[136:139], v[72:75]
    v_mul_f32 v209, v206, v199
    v_fma_f32 v208, -v207, v199, v208
    v_mfma_f32_16x16x32_bf16 v[88:91], v[104:107], v[140:143], v[88:91]
    ds_read_b64_tr_b16 v[104:105], v2 offset:32768
    ds_read_b64_tr_b16 v[106:107], v2 offset:33792
    v_fmac_f32 v209, v207, v198
    v_mfma_f32_16x16x32_bf16 v[44:47], v[108:111], v[128:131], v[44:47]
    v_mul_f32 v196, v194, v198
    v_mul_f32 v197, v194, v199
    v_mfma_f32_16x16x32_bf16 v[60:63], v[108:111], v[132:135], v[60:63]
    s_add_u32 m0, s74, 98304
    s_nop 0
    buffer_load_dwordx4 v9, s[36:39], s73 offen lds
    v_fma_f32 v196, -v195, v199, v196
    v_mfma_f32_16x16x32_bf16 v[76:79], v[108:111], v[136:139], v[76:79]
    v_fmac_f32 v197, v195, v198
    v_cvt_pk_bf16_f32 v230, v208, v209
    v_mfma_f32_16x16x32_bf16 v[92:95], v[108:111], v[140:143], v[92:95]
    ds_read_b64_tr_b16 v[108:109], v2 offset:40960
    ds_read_b64_tr_b16 v[110:111], v2 offset:41984
    v_cvt_pk_bf16_f32 v231, v196, v197
    s_waitcnt lgkmcnt(4)
    v_mfma_f32_16x16x32_bf16 v[32:35], v[96:99], v[112:115], v[32:35]
    buffer_load_dwordx4 v10, s[36:39], s73 offen offset:1024 lds
    s_add_u32 s73, s73, 128
    s_and_b32 s73, s73, 0x3ff
    v_mul_f32 v206, v208, v198
    v_mfma_f32_16x16x32_bf16 v[48:51], v[96:99], v[116:119], v[48:51]
    v_mul_f32 v207, v208, v199
    v_fma_f32 v206, -v209, v199, v206
    v_mfma_f32_16x16x32_bf16 v[64:67], v[96:99], v[120:123], v[64:67]
    v_fmac_f32 v207, v209, v198
    v_mul_f32 v194, v196, v198
    v_mfma_f32_16x16x32_bf16 v[80:83], v[96:99], v[124:127], v[80:83]
    s_waitcnt vmcnt(8) lgkmcnt(0)
    s_barrier
    ds_read_b64_tr_b16 v[96:97], v1 offset:49152
    ds_read_b64_tr_b16 v[98:99], v1 offset:50176
    v_mul_f32 v195, v196, v199
    v_mfma_f32_16x16x32_bf16 v[36:39], v[100:103], v[112:115], v[36:39]
    ds_read_b128 v[140:143], v4 offset:6144
    v_fma_f32 v194, -v197, v199, v194
    v_mfma_f32_16x16x32_bf16 v[52:55], v[100:103], v[116:119], v[52:55]
    ds_read_b128 v[136:139], v4 offset:4096
    s_add_u32 m0, s74, 32768
    s_nop 0
    buffer_load_dwordx4 v7, s[40:43], s72 offen lds
    v_fmac_f32 v195, v197, v198
    v_mfma_f32_16x16x32_bf16 v[68:71], v[100:103], v[120:123], v[68:71]
    ds_read_b128 v[132:135], v4 offset:2048
    v_cvt_pk_bf16_f32 v232, v206, v207
    v_mfma_f32_16x16x32_bf16 v[84:87], v[100:103], v[124:127], v[84:87]
    ds_read_b64_tr_b16 v[100:101], v1 offset:57344
    ds_read_b64_tr_b16 v[102:103], v1 offset:58368
    v_cvt_pk_bf16_f32 v233, v194, v195
    v_mfma_f32_16x16x32_bf16 v[40:43], v[104:107], v[112:115], v[40:43]
    ds_read_b128 v[128:131], v4 offset:0
    buffer_load_dwordx4 v8, s[40:43], s72 offen offset:1024 lds
    s_add_u32 s72, s72, 114688
    s_cmp_eq_u32 s72, 1835008
    s_cmov_b32 s72, 0
    v_mul_f32 v208, v206, v198
    v_mfma_f32_16x16x32_bf16 v[56:59], v[104:107], v[116:119], v[56:59]
    v_mul_f32 v209, v206, v199
    v_fma_f32 v208, -v207, v199, v208
    v_mfma_f32_16x16x32_bf16 v[72:75], v[104:107], v[120:123], v[72:75]
    v_fmac_f32 v209, v207, v198
    v_mul_f32 v196, v194, v198
    v_mfma_f32_16x16x32_bf16 v[88:91], v[104:107], v[124:127], v[88:91]
    ds_read_b64_tr_b16 v[104:105], v2 offset:49152
    ds_read_b64_tr_b16 v[106:107], v2 offset:50176
    v_mul_f32 v197, v194, v199
    v_mfma_f32_16x16x32_bf16 v[44:47], v[108:111], v[112:115], v[44:47]
    v_fma_f32 v196, -v195, v199, v196
    v_fmac_f32 v197, v195, v198
    v_mfma_f32_16x16x32_bf16 v[60:63], v[108:111], v[116:119], v[60:63]
    v_cvt_pk_bf16_f32 v234, v208, v209
    v_cvt_pk_bf16_f32 v235, v196, v197
    v_mfma_f32_16x16x32_bf16 v[76:79], v[108:111], v[120:123], v[76:79]
    v_mul_f32 v206, v208, v198
    v_mul_f32 v207, v208, v199
    v_mfma_f32_16x16x32_bf16 v[92:95], v[108:111], v[124:127], v[92:95]
    ds_read_b64_tr_b16 v[108:109], v2 offset:57344
    ds_read_b64_tr_b16 v[110:111], v2 offset:58368
    v_fma_f32 v206, -v209, v199, v206
    s_waitcnt lgkmcnt(4)
    v_mfma_f32_16x16x32_bf16 v[32:35], v[96:99], v[128:131], v[32:35]
    v_fmac_f32 v207, v209, v198
    v_mul_f32 v194, v196, v198
    v_mfma_f32_16x16x32_bf16 v[48:51], v[96:99], v[132:135], v[48:51]
    v_mul_f32 v195, v196, v199
    v_fma_f32 v194, -v197, v199, v194
    v_mfma_f32_16x16x32_bf16 v[64:67], v[96:99], v[136:139], v[64:67]
    v_fmac_f32 v195, v197, v198
    v_cvt_pk_bf16_f32 v236, v206, v207
    v_mfma_f32_16x16x32_bf16 v[80:83], v[96:99], v[140:143], v[80:83]
    s_waitcnt vmcnt(6) lgkmcnt(0)
    s_barrier
    ds_read_b64_tr_b16 v[96:97], v1 offset:0
    ds_read_b64_tr_b16 v[98:99], v1 offset:1024
    v_cvt_pk_bf16_f32 v237, v194, v195
    v_mfma_f32_16x16x32_bf16 v[36:39], v[100:103], v[128:131], v[36:39]
    ds_read_b128 v[124:127], v3 offset:22528
    v_mul_f32 v208, v206, v198
    v_mfma_f32_16x16x32_bf16 v[52:55], v[100:103], v[132:135], v[52:55]
    ds_read_b128 v[120:123], v3 offset:20480
    s_add_u32 m0, s74, 49152
    s_nop 0
    buffer_load_dwordx4 v7, s[40:43], s72 offen lds
    v_mul_f32 v209, v206, v199
    v_mfma_f32_16x16x32_bf16 v[68:71], v[100:103], v[136:139], v[68:71]
    ds_read_b128 v[116:119], v3 offset:18432
    v_fma_f32 v208, -v207, v199, v208
    v_mfma_f32_16x16x32_bf16 v[84:87], v[100:103], v[140:143], v[84:87]
    ds_read_b64_tr_b16 v[100:101], v1 offset:8192
    ds_read_b64_tr_b16 v[102:103], v1 offset:9216
    v_fmac_f32 v209, v207, v198
    v_mfma_f32_16x16x32_bf16 v[40:43], v[104:107], v[128:131], v[40:43]
    ds_read_b128 v[112:115], v3 offset:16384
    buffer_load_dwordx4 v8, s[40:43], s72 offen offset:1024 lds
    s_add_u32 s72, s72, 114688
    s_cmp_eq_u32 s72, 1835008
    s_cmov_b32 s72, 0
    v_mul_f32 v196, v194, v198
    v_mfma_f32_16x16x32_bf16 v[56:59], v[104:107], v[132:135], v[56:59]
    v_mul_f32 v197, v194, v199
    v_fma_f32 v196, -v195, v199, v196
    v_mfma_f32_16x16x32_bf16 v[72:75], v[104:107], v[136:139], v[72:75]
    v_fmac_f32 v197, v195, v198
    v_cvt_pk_bf16_f32 v238, v208, v209
    v_mfma_f32_16x16x32_bf16 v[88:91], v[104:107], v[140:143], v[88:91]
    ds_read_b64_tr_b16 v[104:105], v2 offset:0
    ds_read_b64_tr_b16 v[106:107], v2 offset:1024
    v_cvt_pk_bf16_f32 v239, v196, v197
    v_mfma_f32_16x16x32_bf16 v[44:47], v[108:111], v[128:131], v[44:47]
    v_mul_f32 v206, v208, v198
    v_mul_f32 v207, v208, v199
    v_mfma_f32_16x16x32_bf16 v[60:63], v[108:111], v[132:135], v[60:63]
    s_add_u32 m0, s74, 65536
    s_nop 0
    buffer_load_dwordx4 v9, s[36:39], s73 offen lds
    v_fma_f32 v206, -v209, v199, v206
    v_mfma_f32_16x16x32_bf16 v[76:79], v[108:111], v[136:139], v[76:79]
    v_fmac_f32 v207, v209, v198
    v_mul_f32 v194, v196, v198
    v_mfma_f32_16x16x32_bf16 v[92:95], v[108:111], v[140:143], v[92:95]
    ds_read_b64_tr_b16 v[108:109], v2 offset:8192
    ds_read_b64_tr_b16 v[110:111], v2 offset:9216
    v_mul_f32 v195, v196, v199
    s_waitcnt lgkmcnt(4)
    v_mfma_f32_16x16x32_bf16 v[32:35], v[96:99], v[112:115], v[32:35]
    buffer_load_dwordx4 v10, s[36:39], s73 offen offset:1024 lds
    s_add_u32 s73, s73, 128
    s_and_b32 s73, s73, 0x3ff
    v_fma_f32 v194, -v197, v199, v194
    v_mfma_f32_16x16x32_bf16 v[48:51], v[96:99], v[116:119], v[48:51]
    v_fmac_f32 v195, v197, v198
    v_cvt_pk_bf16_f32 v240, v206, v207
    v_mfma_f32_16x16x32_bf16 v[64:67], v[96:99], v[120:123], v[64:67]
    v_cvt_pk_bf16_f32 v241, v194, v195
    v_mul_f32 v208, v206, v198
    v_mfma_f32_16x16x32_bf16 v[80:83], v[96:99], v[124:127], v[80:83]
    s_waitcnt vmcnt(8) lgkmcnt(0)
    s_barrier
    ds_read_b64_tr_b16 v[96:97], v1 offset:16384
    ds_read_b64_tr_b16 v[98:99], v1 offset:17408
    v_mul_f32 v209, v206, v199
    v_mfma_f32_16x16x32_bf16 v[36:39], v[100:103], v[112:115], v[36:39]
    ds_read_b128 v[140:143], v4 offset:22528
    v_fma_f32 v208, -v207, v199, v208
    v_mfma_f32_16x16x32_bf16 v[52:55], v[100:103], v[116:119], v[52:55]
    ds_read_b128 v[136:139], v4 offset:20480
    buffer_load_dword v22, v28, s[52:55], 0 offen sc1
    v_fmac_f32 v209, v207, v198
    v_mfma_f32_16x16x32_bf16 v[68:71], v[100:103], v[120:123], v[68:71]
    ds_read_b128 v[132:135], v4 offset:18432
    v_mul_f32 v196, v194, v198
    v_mfma_f32_16x16x32_bf16 v[84:87], v[100:103], v[124:127], v[84:87]
    ds_read_b64_tr_b16 v[100:101], v1 offset:24576
    ds_read_b64_tr_b16 v[102:103], v1 offset:25600
    s_add_u32 m0, s74, 0
    s_nop 0
    buffer_load_dwordx4 v7, s[40:43], s72 offen lds
    v_mul_f32 v197, v194, v199
    v_mfma_f32_16x16x32_bf16 v[40:43], v[104:107], v[112:115], v[40:43]
    ds_read_b128 v[128:131], v4 offset:16384
    v_fma_f32 v196, -v195, v199, v196
    v_mfma_f32_16x16x32_bf16 v[56:59], v[104:107], v[116:119], v[56:59]
    buffer_load_dwordx4 v8, s[40:43], s72 offen offset:1024 lds
    s_add_u32 s72, s72, 114688
    s_cmp_eq_u32 s72, 1835008
    s_cmov_b32 s72, 0
    v_fmac_f32 v197, v195, v198
    v_mfma_f32_16x16x32_bf16 v[72:75], v[104:107], v[120:123], v[72:75]
    v_cvt_pk_bf16_f32 v242, v208, v209
    v_cvt_pk_bf16_f32 v243, v196, v197
    v_mfma_f32_16x16x32_bf16 v[88:91], v[104:107], v[124:127], v[88:91]
    ds_read_b64_tr_b16 v[104:105], v2 offset:16384
    ds_read_b64_tr_b16 v[106:107], v2 offset:17408
    v_mul_f32 v206, v208, v198
    v_mfma_f32_16x16x32_bf16 v[44:47], v[108:111], v[112:115], v[44:47]
    v_mul_f32 v207, v208, v199
    v_fma_f32 v206, -v209, v199, v206
    v_mfma_f32_16x16x32_bf16 v[60:63], v[108:111], v[116:119], v[60:63]
    v_fmac_f32 v207, v209, v198
    v_mul_f32 v194, v196, v198
    v_mfma_f32_16x16x32_bf16 v[76:79], v[108:111], v[120:123], v[76:79]
    v_mul_f32 v195, v196, v199
    v_fma_f32 v194, -v197, v199, v194
    v_mfma_f32_16x16x32_bf16 v[92:95], v[108:111], v[124:127], v[92:95]
    ds_read_b64_tr_b16 v[108:109], v2 offset:24576
    ds_read_b64_tr_b16 v[110:111], v2 offset:25600
    v_fmac_f32 v195, v197, v198
    s_waitcnt lgkmcnt(4)
    v_mfma_f32_16x16x32_bf16 v[32:35], v[96:99], v[128:131], v[32:35]
    v_cvt_pk_bf16_f32 v244, v206, v207
    v_cvt_pk_bf16_f32 v245, v194, v195
    v_mfma_f32_16x16x32_bf16 v[48:51], v[96:99], v[132:135], v[48:51]
    v_mul_f32 v208, v206, v198
    v_mul_f32 v209, v206, v199
    v_mfma_f32_16x16x32_bf16 v[64:67], v[96:99], v[136:139], v[64:67]
    v_fma_f32 v208, -v207, v199, v208
    v_fmac_f32 v209, v207, v198
    v_mfma_f32_16x16x32_bf16 v[80:83], v[96:99], v[140:143], v[80:83]
    s_waitcnt vmcnt(7) lgkmcnt(0)
    s_barrier
    ds_read_b64_tr_b16 v[96:97], v1 offset:32768
    ds_read_b64_tr_b16 v[98:99], v1 offset:33792
    v_mul_f32 v196, v194, v198
    v_mfma_f32_16x16x32_bf16 v[36:39], v[100:103], v[128:131], v[36:39]
    ds_read_b128 v[124:127], v3 offset:38912
    v_mul_f32 v197, v194, v199
    v_mfma_f32_16x16x32_bf16 v[52:55], v[100:103], v[132:135], v[52:55]
    ds_read_b128 v[120:123], v3 offset:36864
    s_add_u32 m0, s74, 16384
    s_nop 0
    buffer_load_dwordx4 v7, s[40:43], s72 offen lds
    v_fma_f32 v196, -v195, v199, v196
    v_mfma_f32_16x16x32_bf16 v[68:71], v[100:103], v[136:139], v[68:71]
    ds_read_b128 v[116:119], v3 offset:34816
    v_fmac_f32 v197, v195, v198
    v_mfma_f32_16x16x32_bf16 v[84:87], v[100:103], v[140:143], v[84:87]
    ds_read_b64_tr_b16 v[100:101], v1 offset:40960
    ds_read_b64_tr_b16 v[102:103], v1 offset:41984
    v_cvt_pk_bf16_f32 v246, v208, v209
    v_mfma_f32_16x16x32_bf16 v[40:43], v[104:107], v[128:131], v[40:43]
    ds_read_b128 v[112:115], v3 offset:32768
    buffer_load_dwordx4 v8, s[40:43], s72 offen offset:1024 lds
    s_add_u32 s72, s72, 114688
    s_cmp_eq_u32 s72, 1835008
    s_cmov_b32 s72, 0
    v_cvt_pk_bf16_f32 v247, v196, v197
    v_mfma_f32_16x16x32_bf16 v[56:59], v[104:107], v[132:135], v[56:59]
    v_mul_f32 v206, v208, v198
    v_mul_f32 v207, v208, v199
    v_mfma_f32_16x16x32_bf16 v[72:75], v[104:107], v[136:139], v[72:75]
    v_fma_f32 v206, -v209, v199, v206
    v_fmac_f32 v207, v209, v198
    v_mfma_f32_16x16x32_bf16 v[88:91], v[104:107], v[140:143], v[88:91]
    ds_read_b64_tr_b16 v[104:105], v2 offset:32768
    ds_read_b64_tr_b16 v[106:107], v2 offset:33792
    v_mul_f32 v194, v196, v198
    v_mfma_f32_16x16x32_bf16 v[44:47], v[108:111], v[128:131], v[44:47]
    v_mul_f32 v195, v196, v199
    v_fma_f32 v194, -v197, v199, v194
    v_mfma_f32_16x16x32_bf16 v[60:63], v[108:111], v[132:135], v[60:63]
    s_waitcnt vmcnt(4)
    v_cmp_ne_u32 s[100:101], s63, v22
    s_nop 0
    s_cmp_lg_u64 s[100:101], 0
    s_cbranch_scc1 L_slow_17
L_back_18:
    s_add_u32 m0, s74, 81920
    s_nop 0
    buffer_load_dwordx4 v9, s[36:39], s73 offen lds
    v_fmac_f32 v195, v197, v198
    v_mfma_f32_16x16x32_bf16 v[76:79], v[108:111], v[136:139], v[76:79]
    v_cvt_pk_bf16_f32 v248, v206, v207
    v_cvt_pk_bf16_f32 v249, v194, v195
    v_mfma_f32_16x16x32_bf16 v[92:95], v[108:111], v[140:143], v[92:95]
    ds_read_b64_tr_b16 v[108:109], v2 offset:40960
    ds_read_b64_tr_b16 v[110:111], v2 offset:41984
    v_mul_f32 v208, v206, v198
    s_waitcnt lgkmcnt(4)
    v_mfma_f32_16x16x32_bf16 v[32:35], v[96:99], v[112:115], v[32:35]
    buffer_load_dwordx4 v10, s[36:39], s73 offen offset:1024 lds
    s_add_u32 s73, s73, 128
    s_and_b32 s73, s73, 0x3ff
    v_mul_f32 v209, v206, v199
    v_mfma_f32_16x16x32_bf16 v[48:51], v[96:99], v[116:119], v[48:51]
    v_fma_f32 v208, -v207, v199, v208
    v_fmac_f32 v209, v207, v198
    v_mfma_f32_16x16x32_bf16 v[64:67], v[96:99], v[120:123], v[64:67]
    v_mul_f32 v196, v194, v198
    v_mul_f32 v197, v194, v199
    v_mfma_f32_16x16x32_bf16 v[80:83], v[96:99], v[124:127], v[80:83]
    s_waitcnt lgkmcnt(0)
    s_barrier
    ds_read_b64_tr_b16 v[96:97], v1 offset:49152
    ds_read_b64_tr_b16 v[98:99], v1 offset:50176
    s_lshr_b32 s65, s91, 8
    v_mfma_f32_16x16x32_bf16 v[36:39], v[100:103], v[112:115], v[36:39]
    ds_read_b128 v[140:143], v4 offset:38912
    s_and_b32 s65, s65, 31
    v_mfma_f32_16x16x32_bf16 v[52:55], v[100:103], v[116:119], v[52:55]
    ds_read_b128 v[136:139], v4 offset:36864
    s_add_u32 m0, s74, 32768
    s_nop 0
    buffer_load_dwordx4 v7, s[40:43], s72 offen lds
    s_lshl_b32 s64, s60, 2
    v_mfma_f32_16x16x32_bf16 v[68:71], v[100:103], v[120:123], v[68:71]
    ds_read_b128 v[132:135], v4 offset:34816
    v_add_u32 v28, s64, v0
    v_mfma_f32_16x16x32_bf16 v[84:87], v[100:103], v[124:127], v[84:87]
    ds_read_b64_tr_b16 v[100:101], v1 offset:57344
    ds_read_b64_tr_b16 v[102:103], v1 offset:58368
    buffer_load_dwordx4 v8, s[40:43], s72 offen offset:1024 lds
    s_add_u32 s72, s72, 114688
    s_cmp_eq_u32 s72, 1835008
    s_cmov_b32 s72, 0
    v_min_u32 v28, 31, v28
    v_mfma_f32_16x16x32_bf16 v[40:43], v[104:107], v[112:115], v[40:43]
    ds_read_b128 v[128:131], v4 offset:32768
    v_mov_b32 v24, s65
    v_mfma_f32_16x16x32_bf16 v[56:59], v[104:107], v[116:119], v[56:59]
    s_add_u32 s79, s78, s9
    buffer_load_dwordx4 v[144:147], v30, s[52:55], s79 offen offset:0 sc1
    v_cmp_gt_u32 vcc, 5, v0
    v_mfma_f32_16x16x32_bf16 v[72:75], v[104:107], v[120:123], v[72:75]
    s_nop 0
    v_cndmask_b32 v28, v24, v28, vcc
    v_lshlrev_b32 v28, 7, v28
    v_mfma_f32_16x16x32_bf16 v[88:91], v[104:107], v[124:127], v[88:91]
    ds_read_b64_tr_b16 v[104:105], v2 offset:49152
    ds_read_b64_tr_b16 v[106:107], v2 offset:50176
    v_add_u32 v28, 102400, v28
    v_mfma_f32_16x16x32_bf16 v[44:47], v[108:111], v[112:115], v[44:47]
    v_fma_f32 v196, -v195, v199, v196
    v_fmac_f32 v197, v195, v198
    v_mfma_f32_16x16x32_bf16 v[60:63], v[108:111], v[116:119], v[60:63]
    buffer_load_dwordx4 v[148:151], v30, s[52:55], s79 offen offset:1024 sc1
    v_cvt_pk_bf16_f32 v250, v208, v209
    v_mfma_f32_16x16x32_bf16 v[76:79], v[108:111], v[120:123], v[76:79]
    v_cvt_pk_bf16_f32 v251, v196, v197
    v_mul_f32 v206, v208, v198
    v_mfma_f32_16x16x32_bf16 v[92:95], v[108:111], v[124:127], v[92:95]
    ds_read_b64_tr_b16 v[108:109], v2 offset:57344
    ds_read_b64_tr_b16 v[110:111], v2 offset:58368
    v_mul_f32 v207, v208, v199
    s_waitcnt lgkmcnt(4)
    v_mfma_f32_16x16x32_bf16 v[32:35], v[96:99], v[128:131], v[32:35]
    v_fma_f32 v206, -v209, v199, v206
    v_fmac_f32 v207, v209, v198
    v_mfma_f32_16x16x32_bf16 v[48:51], v[96:99], v[132:135], v[48:51]
    v_mul_f32 v194, v196, v198
    v_mul_f32 v195, v196, v199
    v_mfma_f32_16x16x32_bf16 v[64:67], v[96:99], v[136:139], v[64:67]
    v_fma_f32 v194, -v197, v199, v194
    v_fmac_f32 v195, v197, v198
    v_mfma_f32_16x16x32_bf16 v[80:83], v[96:99], v[140:143], v[80:83]
    s_waitcnt vmcnt(8) lgkmcnt(0)
    s_barrier
    ds_read_b64_tr_b16 v[96:97], v1 offset:0
    ds_read_b64_tr_b16 v[98:99], v1 offset:1024
    v_cvt_pk_bf16_f32 v252, v206, v207
    v_mfma_f32_16x16x32_bf16 v[36:39], v[100:103], v[128:131], v[36:39]
    ds_read_b128 v[124:127], v3 offset:6144
    v_cvt_pk_bf16_f32 v253, v194, v195
    v_mfma_f32_16x16x32_bf16 v[52:55], v[100:103], v[132:135], v[52:55]
    ds_read_b128 v[120:123], v3 offset:4096
    buffer_load_dword v22, v28, s[52:55], 0 offen sc1
    v_mul_f32 v208, v206, v198
    v_mfma_f32_16x16x32_bf16 v[68:71], v[100:103], v[136:139], v[68:71]
    ds_read_b128 v[116:119], v3 offset:2048
    s_add_u32 m0, s74, 49152
    s_nop 0
    buffer_load_dwordx4 v7, s[40:43], s72 offen lds
    v_mul_f32 v209, v206, v199
    v_mfma_f32_16x16x32_bf16 v[84:87], v[100:103], v[140:143], v[84:87]
    ds_read_b64_tr_b16 v[100:101], v1 offset:8192
    ds_read_b64_tr_b16 v[102:103], v1 offset:9216
    v_fma_f32 v208, -v207, v199, v208
    v_mfma_f32_16x16x32_bf16 v[40:43], v[104:107], v[128:131], v[40:43]
    ds_read_b128 v[112:115], v3 offset:0
    buffer_load_dwordx4 v8, s[40:43], s72 offen offset:1024 lds
    s_add_u32 s72, s72, 114688
    s_cmp_eq_u32 s72, 1835008
    s_cmov_b32 s72, 0
    v_fmac_f32 v209, v207, v198
    v_mfma_f32_16x16x32_bf16 v[56:59], v[104:107], v[132:135], v[56:59]
    buffer_load_dwordx4 v[152:155], v30, s[52:55], s79 offen offset:2048 sc1
    v_mul_f32 v196, v194, v198
    v_mfma_f32_16x16x32_bf16 v[72:75], v[104:107], v[136:139], v[72:75]
    v_mul_f32 v197, v194, v199
    v_fma_f32 v196, -v195, v199, v196
    v_mfma_f32_16x16x32_bf16 v[88:91], v[104:107], v[140:143], v[88:91]
    ds_read_b64_tr_b16 v[104:105], v2 offset:0
    ds_read_b64_tr_b16 v[106:107], v2 offset:1024
    v_fmac_f32 v197, v195, v198
    v_mfma_f32_16x16x32_bf16 v[44:47], v[108:111], v[128:131], v[44:47]
    v_cvt_pk_bf16_f32 v254, v208, v209
    v_cvt_pk_bf16_f32 v255, v196, v197
    v_mfma_f32_16x16x32_bf16 v[60:63], v[108:111], v[132:135], v[60:63]
    buffer_load_dwordx4 v[156:159], v30, s[52:55], s79 offen offset:3072 sc1
    s_add_u32 s9, s9, 4096
    s_cmp_eq_u32 s9, 28672
    s_cmov_b32 s9, 0
    v_lshl_add_u32 v29, v0, 2, s92
    v_mfma_f32_16x16x32_bf16 v[76:79], v[108:111], v[136:139], v[76:79]
    v_and_b32 v24, 15, v0
    v_lshrrev_b32 v25, 4, v0
    v_mfma_f32_16x16x32_bf16 v[92:95], v[108:111], v[140:143], v[92:95]
    ds_read_b64_tr_b16 v[108:109], v2 offset:8192
    ds_read_b64_tr_b16 v[110:111], v2 offset:9216
    v_mul_u32_u24 v220, 288, v24
    s_waitcnt lgkmcnt(4)
    v_mfma_f32_16x16x32_bf16 v[32:35], v[96:99], v[112:115], v[32:35]
    s_add_u32 s79, s78, s9
    buffer_load_dwordx4 v[160:163], v30, s[52:55], s79 offen offset:0 sc1
    v_lshl_add_u32 v220, v25, 4, v220
    v_mfma_f32_16x16x32_bf16 v[48:51], v[96:99], v[116:119], v[48:51]
    v_lshl_add_u32 v208, s4, 9, v220
    v_lshl_add_u32 v209, s5, 9, v220
    v_mfma_f32_16x16x32_bf16 v[64:67], v[96:99], v[120:123], v[64:67]
    v_lshl_add_u32 v210, s6, 9, v220
    v_lshl_add_u32 v211, s7, 9, v220
    v_mfma_f32_16x16x32_bf16 v[80:83], v[96:99], v[124:127], v[80:83]
    s_waitcnt vmcnt(12) lgkmcnt(0)
    s_barrier
    ds_read_b64_tr_b16 v[96:97], v1 offset:16384
    ds_read_b64_tr_b16 v[98:99], v1 offset:17408
    v_add_u32 v220, 1, v24
    v_mfma_f32_16x16x32_bf16 v[36:39], v[100:103], v[112:115], v[36:39]
    ds_read_b128 v[140:143], v4 offset:6144
    v_and_b32 v221, 3, v220
    v_mfma_f32_16x16x32_bf16 v[52:55], v[100:103], v[116:119], v[52:55]
    ds_read_b128 v[136:139], v4 offset:4096
    buffer_load_dwordx2 v[20:21], v14, s[52:55], s90 offen sc1
    v_sub_u32 v220, v220, v221
    v_mfma_f32_16x16x32_bf16 v[68:71], v[100:103], v[120:123], v[68:71]
    ds_read_b128 v[132:135], v4 offset:2048
    v_lshl_add_u32 v220, v25, 3, v220
    v_mfma_f32_16x16x32_bf16 v[84:87], v[100:103], v[124:127], v[84:87]
    ds_read_b64_tr_b16 v[100:101], v1 offset:24576
    ds_read_b64_tr_b16 v[102:103], v1 offset:25600
    v_mul_u32_u24 v221, 4160, v221
    v_mfma_f32_16x16x32_bf16 v[40:43], v[104:107], v[112:115], v[40:43]
    ds_read_b128 v[128:131], v4 offset:0
    buffer_load_dwordx4 v[164:167], v30, s[52:55], s79 offen offset:1024 sc1
    v_lshl_add_u32 v218, v220, 1, v221
    v_mfma_f32_16x16x32_bf16 v[56:59], v[104:107], v[116:119], v[56:59]
    v_lshlrev_b32 v220, 5, v24
    v_lshlrev_b32 v221, 4, v25
    v_mfma_f32_16x16x32_bf16 v[72:75], v[104:107], v[120:123], v[72:75]
    v_sub_u32 v219, v221, v220
    v_lshl_add_u32 v24, s77, 4, v24
    v_mfma_f32_16x16x32_bf16 v[88:91], v[104:107], v[124:127], v[88:91]
    ds_read_b64_tr_b16 v[104:105], v2 offset:16384
    ds_read_b64_tr_b16 v[106:107], v2 offset:17408
    s_mul_i32 s64, s86, 4608
    v_mfma_f32_16x16x32_bf16 v[44:47], v[108:111], v[112:115], v[44:47]
    s_add_u32 s65, s64, 118784
    v_lshl_add_u32 v212, v13, 2, s65
    v_mfma_f32_16x16x32_bf16 v[60:63], v[108:111], v[116:119], v[60:63]
    s_waitcnt vmcnt(7)
    v_cmp_ne_u32 s[100:101], s63, v22
    s_nop 0
    s_cmp_lg_u64 s[100:101], 0
    s_cbranch_scc1 L_slow_20
L_back_21:
    buffer_load_dwordx4 v[16:19], v6, s[52:55], s91 offen sc1
    v_mov_b32 v220, 0
    v_mfma_f32_16x16x32_bf16 v[76:79], v[108:111], v[120:123], v[76:79]
    v_mov_b32 v221, 0
    v_mov_b32 v222, 0
    v_mfma_f32_16x16x32_bf16 v[92:95], v[108:111], v[124:127], v[92:95]
    ds_read_b64_tr_b16 v[108:109], v2 offset:24576
    ds_read_b64_tr_b16 v[110:111], v2 offset:25600
    v_mov_b32 v223, 0
    s_waitcnt lgkmcnt(4)
    v_mfma_f32_16x16x32_bf16 v[32:35], v[96:99], v[128:131], v[32:35]
    buffer_load_dwordx4 v[168:171], v30, s[52:55], s79 offen offset:2048 sc1
    ds_write_b128 v212, v[220:223]
    v_mfma_f32_16x16x32_bf16 v[48:51], v[96:99], v[132:135], v[48:51]
    v_cmp_gt_u32 s[70:71], 32, v0
    v_add_u32 v212, 2, v25
    v_mfma_f32_16x16x32_bf16 v[64:67], v[96:99], v[136:139], v[64:67]
    v_lshlrev_b32 v25, 1, v25
    v_cndmask_b32 v212, v25, v212, s[70:71]
    v_lshlrev_b32 v212, 9, v212
    v_lshl_add_u32 v212, v24, 4, v212
    s_add_u32 s65, s64, 118256
    v_sub_u32 v212, s65, v212
    v_mov_b32 v213, 0x3020302
    v_mov_b32 v24, 0x5040504
    v_mov_b32 v25, 0x1000302
    v_mov_b32 v214, 0x1000100
    v_cndmask_b32 v215, v213, v24, s[70:71]
    v_cndmask_b32 v216, v214, v25, s[70:71]
    v_and_b32 v24, 33, v0
    v_cmp_eq_u32 s[70:71], 32, v24
    s_nop 1
    v_cndmask_b32 v217, v213, v25, s[70:71]
    v_mfma_f32_16x16x32_bf16 v[80:83], v[96:99], v[140:143], v[80:83]
    s_waitcnt lgkmcnt(0)
    s_barrier
    ds_read_b64_tr_b16 v[96:97], v1 offset:32768
    ds_read_b64_tr_b16 v[98:99], v1 offset:33792
    v_mfma_f32_16x16x32_bf16 v[36:39], v[100:103], v[128:131], v[36:39]
    ds_read_b128 v[124:127], v3 offset:22528
    v_mfma_f32_16x16x32_bf16 v[52:55], v[100:103], v[132:135], v[52:55]
    ds_read_b128 v[120:123], v3 offset:20480
    buffer_load_dwordx4 v[8:11], v12, s[52:55], s89 offen sc1
    s_add_u32 s95, s89, 65312
    v_mfma_f32_16x16x32_bf16 v[68:71], v[100:103], v[136:139], v[68:71]
    ds_read_b128 v[116:119], v3 offset:18432
    v_mfma_f32_16x16x32_bf16 v[84:87], v[100:103], v[140:143], v[84:87]
    ds_read_b64_tr_b16 v[100:101], v1 offset:40960
    ds_read_b64_tr_b16 v[102:103], v1 offset:41984
    s_mov_b32 exec_lo, 0xc000c000
    s_mov_b32 exec_hi, 0xc000c000
    buffer_load_dwordx2 v[26:27], v12, s[52:55], s95 offen sc1
    s_mov_b64 exec, -1
    v_mfma_f32_16x16x32_bf16 v[40:43], v[104:107], v[128:131], v[40:43]
    ds_read_b128 v[112:115], v3 offset:16384
    v_mfma_f32_16x16x32_bf16 v[56:59], v[104:107], v[132:135], v[56:59]
    buffer_load_dwordx4 v[172:175], v30, s[52:55], s79 offen offset:3072 sc1
    s_add_u32 s9, s9, 4096
    s_cmp_eq_u32 s9, 28672
    s_cmov_b32 s9, 0
    v_mfma_f32_16x16x32_bf16 v[72:75], v[104:107], v[136:139], v[72:75]
    v_mfma_f32_16x16x32_bf16 v[88:91], v[104:107], v[140:143], v[88:91]
    ds_read_b64_tr_b16 v[104:105], v2 offset:32768
    ds_read_b64_tr_b16 v[106:107], v2 offset:33792
    v_mfma_f32_16x16x32_bf16 v[44:47], v[108:111], v[128:131], v[44:47]
    v_mfma_f32_16x16x32_bf16 v[60:63], v[108:111], v[132:135], v[60:63]
    s_waitcnt vmcnt(6)
    v_cmp_ne_u32 s[100:101], s63, v21
    s_nop 0
    s_cmp_lg_u64 s[100:101], 0
    s_cbranch_scc1 L_slow_23
L_back_24:
    ds_write_b32 v29, v20
    v_mfma_f32_16x16x32_bf16 v[76:79], v[108:111], v[136:139], v[76:79]
    v_mfma_f32_16x16x32_bf16 v[92:95], v[108:111], v[140:143], v[92:95]
    ds_read_b64_tr_b16 v[108:109], v2 offset:40960
    ds_read_b64_tr_b16 v[110:111], v2 offset:41984
    s_waitcnt lgkmcnt(5)
    v_mfma_f32_16x16x32_bf16 v[32:35], v[96:99], v[112:115], v[32:35]
    s_add_u32 s79, s78, s9
    buffer_load_dwordx4 v[176:179], v30, s[52:55], s79 offen offset:0 sc1
    v_mfma_f32_16x16x32_bf16 v[36:39], v[100:103], v[112:115], v[36:39]
    s_waitcnt lgkmcnt(3)
    v_mfma_f32_16x16x32_bf16 v[40:43], v[104:107], v[112:115], v[40:43]
    s_waitcnt lgkmcnt(0)
    v_mfma_f32_16x16x32_bf16 v[44:47], v[108:111], v[112:115], v[44:47]
    s_barrier
    ds_read_b64_tr_b16 v[128:129], v1 offset:49152
    ds_read_b64_tr_b16 v[130:131], v1 offset:50176
    v_mfma_f32_16x16x32_bf16 v[48:51], v[96:99], v[116:119], v[48:51]
    ds_read_b64_tr_b16 v[132:133], v1 offset:57344
    ds_read_b64_tr_b16 v[134:135], v1 offset:58368
    ds_read_b128 v[112:115], v4 offset:16384
    v_mfma_f32_16x16x32_bf16 v[52:55], v[100:103], v[116:119], v[52:55]
    ds_read_b64_tr_b16 v[136:137], v2 offset:49152
    ds_read_b64_tr_b16 v[138:139], v2 offset:50176
    ds_read_b128 v[192:195], v5 offset:0
    v_mfma_f32_16x16x32_bf16 v[56:59], v[104:107], v[116:119], v[56:59]
    ds_read_b64_tr_b16 v[140:141], v2 offset:57344
    ds_read_b64_tr_b16 v[142:143], v2 offset:58368
    ds_read_b128 v[196:199], v5 offset:64
    v_mfma_f32_16x16x32_bf16 v[60:63], v[108:111], v[116:119], v[60:63]
    ds_read_b128 v[200:203], v5 offset:128
    s_mov_b32 m0, s80
    s_nop 0
    ds_write_addtid_b32 v224 offset:0
    ds_write_addtid_b32 v226 offset:288
    s_waitcnt lgkmcnt(9)
    v_mfma_f32_16x16x32_bf16 v[32:35], v[128:131], v[112:115], v[32:35]
    ds_read_b128 v[116:119], v4 offset:18432
    ds_read_b128 v[204:207], v5 offset:192
    ds_write_addtid_b32 v228 offset:576
    ds_write_addtid_b32 v230 offset:864
    ds_write_addtid_b32 v232 offset:1152
    v_mfma_f32_16x16x32_bf16 v[36:39], v[132:135], v[112:115], v[36:39]
    buffer_load_dwordx4 v[180:183], v30, s[52:55], s79 offen offset:1024 sc1
    ds_write_addtid_b32 v234 offset:1440
    ds_write_addtid_b32 v236 offset:1728
    ds_write_addtid_b32 v238 offset:2016
    s_waitcnt lgkmcnt(15)
    v_mfma_f32_16x16x32_bf16 v[40:43], v[136:139], v[112:115], v[40:43]
    buffer_load_dwordx4 v[184:187], v30, s[52:55], s79 offen offset:2048 sc1
    ds_write_addtid_b32 v240 offset:2304
    ds_write_addtid_b32 v242 offset:2592
    ds_write_addtid_b32 v244 offset:2880
    s_waitcnt lgkmcnt(15)
    v_mfma_f32_16x16x32_bf16 v[44:47], v[140:143], v[112:115], v[44:47]
    ds_write_addtid_b32 v246 offset:3168
    ds_write_addtid_b32 v248 offset:3456
    ds_write_addtid_b32 v250 offset:3744
    s_waitcnt lgkmcnt(13)
    v_mfma_f32_16x16x32_bf16 v[48:51], v[128:131], v[116:119], v[48:51]
    ds_read_b128 v[112:115], v4 offset:20480
    ds_write_addtid_b32 v252 offset:4032
    ds_write_addtid_b32 v254 offset:4320
    s_mov_b32 m0, s8
    v_mfma_f32_16x16x32_bf16 v[52:55], v[132:135], v[116:119], v[52:55]
    buffer_load_dwordx4 v[188:191], v30, s[52:55], s79 offen offset:3072 sc1
    s_add_u32 s9, s9, 4096
    s_cmp_eq_u32 s9, 28672
    s_cmov_b32 s9, 0
    ds_write_addtid_b32 v225 offset:0
    ds_write_addtid_b32 v227 offset:288
    ds_write_addtid_b32 v229 offset:576
    v_mfma_f32_16x16x32_bf16 v[56:59], v[136:139], v[116:119], v[56:59]
    s_waitcnt vmcnt(8)
    v_fma_f32 v32, -v192, v16, v32
    v_fma_f32 v33, -v193, v16, v33
    v_fma_f32 v34, -v194, v16, v34
    v_mfma_f32_16x16x32_bf16 v[60:63], v[140:143], v[116:119], v[60:63]
    v_fma_f32 v35, -v195, v16, v35
    v_fma_f32 v36, -v196, v16, v36
    v_fma_f32 v37, -v197, v16, v37
    v_mfma_f32_16x16x32_bf16 v[64:67], v[96:99], v[120:123], v[64:67]
    ds_read_b128 v[116:119], v4 offset:22528
    v_fma_f32 v38, -v198, v16, v38
    v_fma_f32 v39, -v199, v16, v39
    v_fma_f32 v40, -v200, v16, v40
    v_mfma_f32_16x16x32_bf16 v[68:71], v[100:103], v[120:123], v[68:71]
    v_fma_f32 v41, -v201, v16, v41
    v_fma_f32 v42, -v202, v16, v42
    v_fma_f32 v43, -v203, v16, v43
    v_mfma_f32_16x16x32_bf16 v[72:75], v[104:107], v[120:123], v[72:75]
    s_waitcnt lgkmcnt(15)
    v_fma_f32 v44, -v204, v16, v44
    v_fma_f32 v45, -v205, v16, v45
    v_fma_f32 v46, -v206, v16, v46
    v_mfma_f32_16x16x32_bf16 v[76:79], v[108:111], v[120:123], v[76:79]
    v_fma_f32 v47, -v207, v16, v47
    v_max_f32 v32, 0, v32
    v_max_f32 v33, 0, v33
    s_waitcnt lgkmcnt(6)
    v_mfma_f32_16x16x32_bf16 v[64:67], v[128:131], v[112:115], v[64:67]
    v_max_f32 v34, 0, v34
    v_max_f32 v35, 0, v35
    v_max_f32 v40, 0, v40
    v_mfma_f32_16x16x32_bf16 v[68:71], v[132:135], v[112:115], v[68:71]
    v_max_f32 v41, 0, v41
    v_max_f32 v42, 0, v42
    v_max_f32 v43, 0, v43
    v_mfma_f32_16x16x32_bf16 v[72:75], v[136:139], v[112:115], v[72:75]
    v_mul_f32 v32, v32, v36
    v_mul_f32 v33, v33, v37
    v_mul_f32 v34, v34, v38
    v_mfma_f32_16x16x32_bf16 v[76:79], v[140:143], v[112:115], v[76:79]
    v_mul_f32 v35, v35, v39
    v_mul_f32 v40, v40, v44
    v_mul_f32 v41, v41, v45
    v_mfma_f32_16x16x32_bf16 v[80:83], v[96:99], v[124:127], v[80:83]
    v_mul_f32 v42, v42, v46
    v_mul_f32 v43, v43, v47
    v_cvt_pk_bf16_f32 v32, v32, v33
    v_mfma_f32_16x16x32_bf16 v[84:87], v[100:103], v[124:127], v[84:87]
    v_cvt_pk_bf16_f32 v33, v34, v35
    v_cvt_pk_bf16_f32 v34, v40, v41
    v_cvt_pk_bf16_f32 v35, v42, v43
    v_mfma_f32_16x16x32_bf16 v[88:91], v[104:107], v[124:127], v[88:91]
    buffer_store_dwordx4 v[32:35], v30, s[52:55], s84 offen sc1
    s_add_u32 s84, s84, 57344
    v_pk_fma_f32 v[48:49], v[192:193], v[16:17], v[48:49] op_sel:[0,1,0] op_sel_hi:[1,1,1] neg_lo:[0,1,0] neg_hi:[0,1,0]
    v_mfma_f32_16x16x32_bf16 v[92:95], v[108:111], v[124:127], v[92:95]
    v_pk_fma_f32 v[50:51], v[194:195], v[16:17], v[50:51] op_sel:[0,1,0] op_sel_hi:[1,1,1] neg_lo:[0,1,0] neg_hi:[0,1,0]
    v_pk_fma_f32 v[52:53], v[196:197], v[16:17], v[52:53] op_sel:[0,1,0] op_sel_hi:[1,1,1] neg_lo:[0,1,0] neg_hi:[0,1,0]
    v_pk_fma_f32 v[54:55], v[198:199], v[16:17], v[54:55] op_sel:[0,1,0] op_sel_hi:[1,1,1] neg_lo:[0,1,0] neg_hi:[0,1,0]
    s_waitcnt lgkmcnt(0)
    v_mfma_f32_16x16x32_bf16 v[80:83], v[128:131], v[116:119], v[80:83]
    v_pk_fma_f32 v[56:57], v[200:201], v[16:17], v[56:57] op_sel:[0,1,0] op_sel_hi:[1,1,1] neg_lo:[0,1,0] neg_hi:[0,1,0]
    v_pk_fma_f32 v[58:59], v[202:203], v[16:17], v[58:59] op_sel:[0,1,0] op_sel_hi:[1,1,1] neg_lo:[0,1,0] neg_hi:[0,1,0]
    v_pk_fma_f32 v[60:61], v[204:205], v[16:17], v[60:61] op_sel:[0,1,0] op_sel_hi:[1,1,1] neg_lo:[0,1,0] neg_hi:[0,1,0]
    v_mfma_f32_16x16x32_bf16 v[84:87], v[132:135], v[116:119], v[84:87]
    v_pk_fma_f32 v[62:63], v[206:207], v[16:17], v[62:63] op_sel:[0,1,0] op_sel_hi:[1,1,1] neg_lo:[0,1,0] neg_hi:[0,1,0]
    v_max_f32 v48, 0, v48
    v_max_f32 v49, 0, v49
    v_mfma_f32_16x16x32_bf16 v[88:91], v[136:139], v[116:119], v[88:91]
    v_max_f32 v50, 0, v50
    v_max_f32 v51, 0, v51
    v_max_f32 v56, 0, v56
    v_mfma_f32_16x16x32_bf16 v[92:95], v[140:143], v[116:119], v[92:95]
    v_max_f32 v57, 0, v57
    v_max_f32 v58, 0, v58
    v_max_f32 v59, 0, v59
    v_pk_mul_f32 v[48:49], v[48:49], v[52:53]
    v_pk_mul_f32 v[50:51], v[50:51], v[54:55]
    v_pk_mul_f32 v[56:57], v[56:57], v[60:61]
    v_pk_mul_f32 v[58:59], v[58:59], v[62:63]
    v_cvt_pk_bf16_f32 v48, v48, v49
    v_cvt_pk_bf16_f32 v49, v50, v51
    v_cvt_pk_bf16_f32 v50, v56, v57
    v_cvt_pk_bf16_f32 v51, v58, v59
    buffer_store_dwordx4 v[48:51], v30, s[52:55], s84 offen sc1
    s_add_u32 s84, s84, 57344
    v_pk_fma_f32 v[64:65], v[192:193], v[18:19], v[64:65] op_sel:[0,0,0] op_sel_hi:[1,0,1] neg_lo:[0,1,0] neg_hi:[0,1,0]
    v_pk_fma_f32 v[66:67], v[194:195], v[18:19], v[66:67] op_sel:[0,0,0] op_sel_hi:[1,0,1] neg_lo:[0,1,0] neg_hi:[0,1,0]
    v_pk_fma_f32 v[68:69], v[196:197], v[18:19], v[68:69] op_sel:[0,0,0] op_sel_hi:[1,0,1] neg_lo:[0,1,0] neg_hi:[0,1,0]
    v_pk_fma_f32 v[70:71], v[198:199], v[18:19], v[70:71] op_sel:[0,0,0] op_sel_hi:[1,0,1] neg_lo:[0,1,0] neg_hi:[0,1,0]
    v_pk_fma_f32 v[72:73], v[200:201], v[18:19], v[72:73] op_sel:[0,0,0] op_sel_hi:[1,0,1] neg_lo:[0,1,0] neg_hi:[0,1,0]
    v_pk_fma_f32 v[74:75], v[202:203], v[18:19], v[74:75] op_sel:[0,0,0] op_sel_hi:[1,0,1] neg_lo:[0,1,0] neg_hi:[0,1,0]
    v_pk_fma_f32 v[76:77], v[204:205], v[18:19], v[76:77] op_sel:[0,0,0] op_sel_hi:[1,0,1] neg_lo:[0,1,0] neg_hi:[0,1,0]
    v_pk_fma_f32 v[78:79], v[206:207], v[18:19], v[78:79] op_sel:[0,0,0] op_sel_hi:[1,0,1] neg_lo:[0,1,0] neg_hi:[0,1,0]
    v_max_f32 v64, 0, v64
    v_max_f32 v65, 0, v65
    v_max_f32 v66, 0, v66
    v_max_f32 v67, 0, v67
    v_max_f32 v72, 0, v72
    v_max_f32 v73, 0, v73
    v_max_f32 v74, 0, v74
    v_max_f32 v75, 0, v75
    v_pk_mul_f32 v[64:65], v[64:65], v[68:69]
    v_pk_mul_f32 v[66:67], v[66:67], v[70:71]
    v_pk_mul_f32 v[72:73], v[72:73], v[76:77]
    v_pk_mul_f32 v[74:75], v[74:75], v[78:79]
    v_cvt_pk_bf16_f32 v64, v64, v65
    v_cvt_pk_bf16_f32 v65, v66, v67
    v_cvt_pk_bf16_f32 v66, v72, v73
    v_cvt_pk_bf16_f32 v67, v74, v75
    buffer_store_dwordx4 v[64:67], v30, s[52:55], s84 offen sc1
    s_add_u32 s84, s84, 57344
    v_pk_fma_f32 v[80:81], v[192:193], v[18:19], v[80:81] op_sel:[0,1,0] op_sel_hi:[1,1,1] neg_lo:[0,1,0] neg_hi:[0,1,0]
    v_pk_fma_f32 v[82:83], v[194:195], v[18:19], v[82:83] op_sel:[0,1,0] op_sel_hi:[1,1,1] neg_lo:[0,1,0] neg_hi:[0,1,0]
    v_pk_fma_f32 v[84:85], v[196:197], v[18:19], v[84:85] op_sel:[0,1,0] op_sel_hi:[1,1,1] neg_lo:[0,1,0] neg_hi:[0,1,0]
    v_pk_fma_f32 v[86:87], v[198:199], v[18:19], v[86:87] op_sel:[0,1,0] op_sel_hi:[1,1,1] neg_lo:[0,1,0] neg_hi:[0,1,0]
    v_pk_fma_f32 v[88:89], v[200:201], v[18:19], v[88:89] op_sel:[0,1,0] op_sel_hi:[1,1,1] neg_lo:[0,1,0] neg_hi:[0,1,0]
    v_pk_fma_f32 v[90:91], v[202:203], v[18:19], v[90:91] op_sel:[0,1,0] op_sel_hi:[1,1,1] neg_lo:[0,1,0] neg_hi:[0,1,0]
    v_pk_fma_f32 v[92:93], v[204:205], v[18:19], v[92:93] op_sel:[0,1,0] op_sel_hi:[1,1,1] neg_lo:[0,1,0] neg_hi:[0,1,0]
    v_pk_fma_f32 v[94:95], v[206:207], v[18:19], v[94:95] op_sel:[0,1,0] op_sel_hi:[1,1,1] neg_lo:[0,1,0] neg_hi:[0,1,0]
    v_max_f32 v80, 0, v80
    v_max_f32 v81, 0, v81
    v_max_f32 v82, 0, v82
    v_max_f32 v83, 0, v83
    v_max_f32 v88, 0, v88
    v_max_f32 v89, 0, v89
    v_max_f32 v90, 0, v90
    v_max_f32 v91, 0, v91
    v_pk_mul_f32 v[80:81], v[80:81], v[84:85]
    v_pk_mul_f32 v[82:83], v[82:83], v[86:87]
    v_pk_mul_f32 v[88:89], v[88:89], v[92:93]
    v_pk_mul_f32 v[90:91], v[90:91], v[94:95]
    v_cvt_pk_bf16_f32 v80, v80, v81
    v_cvt_pk_bf16_f32 v81, v82, v83
    v_cvt_pk_bf16_f32 v82, v88, v89
    v_cvt_pk_bf16_f32 v83, v90, v91
    buffer_store_dwordx4 v[80:83], v30, s[52:55], s84 offen sc1
    s_add_u32 s84, s84, 57344
    ds_write_addtid_b32 v231 offset:864
    ds_write_addtid_b32 v233 offset:1152
    ds_write_addtid_b32 v235 offset:1440
    ds_write_addtid_b32 v237 offset:1728
    ds_write_addtid_b32 v239 offset:2016
    ds_write_addtid_b32 v241 offset:2304
    ds_write_addtid_b32 v243 offset:2592
    ds_write_addtid_b32 v245 offset:2880
    ds_write_addtid_b32 v247 offset:3168
    ds_write_addtid_b32 v249 offset:3456
    ds_write_addtid_b32 v251 offset:3744
    ds_write_addtid_b32 v253 offset:4032
    ds_write_addtid_b32 v255 offset:4320
    s_lshl_b32 s64, s93, 8
    s_mul_i32 s65, s86, 16704
    s_add_u32 s65, s65, s64
    s_add_u32 s65, s65, 123904
    v_add_u32 v1, s65, v218
    s_mul_i32 s65, s86, 4608
    s_add_u32 s65, s65, s64
    s_add_u32 s65, s65, 115168
    v_add_u32 v2, s65, v219
    s_waitcnt vmcnt(10)
    ds_write_b128 v31, v[8:11]
    s_waitcnt vmcnt(9)
    v_mov_b32_dpp v26, v8 row_shl:2 row_mask:0xf bank_mask:0xf
    v_mov_b32_dpp v27, v9 row_shl:2 row_mask:0xf bank_mask:0xf
    v_alignbit_b32 v220, v9, v8, 16
    v_alignbit_b32 v221, v10, v9, 16
    v_alignbit_b32 v222, v11, v10, 16
    v_alignbit_b32 v223, v26, v11, 16
    ds_write_b128 v31, v[220:223] offset:4160
    v_mov_b32 v220, v9
    v_mov_b32 v221, v10
    v_mov_b32 v222, v11
    v_mov_b32 v223, v26
    ds_write_b128 v31, v[220:223] offset:8320
    v_alignbit_b32 v220, v10, v9, 16
    v_alignbit_b32 v221, v11, v10, 16
    v_alignbit_b32 v222, v26, v11, 16
    v_alignbit_b32 v223, v27, v26, 16
    ds_write_b128 v31, v[220:223] offset:12480
    s_waitcnt lgkmcnt(0)
    s_barrier
    ds_read_b128 v[224:227], v208 offset:0
    ds_read_b128 v[228:231], v210 offset:0
    ds_read_b128 v[232:235], v208 offset:64
    ds_read_b128 v[236:239], v210 offset:64
    ds_read_b128 v[240:243], v208 offset:128
    ds_read_b128 v[244:247], v210 offset:128
    ds_read_b128 v[248:251], v208 offset:192
    ds_read_b128 v[252:255], v210 offset:192
    s_waitcnt lgkmcnt(6)
    v_mfma_f32_16x16x32_bf16 v[112:115], v[224:227], v[228:231], 0
    ds_read_b128 v[224:227], v209 offset:0
    ds_read_b128 v[228:231], v211 offset:0
    s_waitcnt lgkmcnt(6)
    v_mfma_f32_16x16x32_bf16 v[112:115], v[232:235], v[236:239], v[112:115]
    ds_read_b128 v[232:235], v209 offset:64
    ds_read_b128 v[236:239], v211 offset:64
    s_waitcnt lgkmcnt(6)
    v_mfma_f32_16x16x32_bf16 v[112:115], v[240:243], v[244:247], v[112:115]
    ds_read_b128 v[240:243], v209 offset:128
    ds_read_b128 v[244:247], v211 offset:128
    s_waitcnt lgkmcnt(6)
    v_mfma_f32_16x16x32_bf16 v[112:115], v[248:251], v[252:255], v[112:115]
    ds_read_b128 v[248:251], v209 offset:192
    ds_read_b128 v[252:255], v211 offset:192
    s_waitcnt lgkmcnt(6)
    v_mfma_f32_16x16x32_bf16 v[112:115], v[224:227], v[228:231], v[112:115]
    s_waitcnt lgkmcnt(4)
    v_mfma_f32_16x16x32_bf16 v[112:115], v[232:235], v[236:239], v[112:115]
    s_waitcnt lgkmcnt(2)
    v_mfma_f32_16x16x32_bf16 v[112:115], v[240:243], v[244:247], v[112:115]
    s_waitcnt lgkmcnt(0)
    v_mfma_f32_16x16x32_bf16 v[112:115], v[248:251], v[252:255], v[112:115]
    s_nop 7
    v_cvt_pk_bf16_f32 v124, v112, v113
    v_cvt_pk_bf16_f32 v125, v114, v115
    v_perm_b32 v116, v125, v124, v215
    v_perm_b32 v117, v125, v124, v217
    v_perm_b32 v118, v125, v124, v216
    v_perm_b32 v119, v125, v124, v214
    ds_write_b128 v212, v[116:119] offset:512
    v_perm_b32 v120, v125, v125, v213
    v_perm_b32 v121, v125, v125, v217
    v_perm_b32 v122, v125, v125, v214
    v_perm_b32 v123, v125, v125, v214
    s_mov_b32 exec_lo, 0
    ds_write_b128 v212, v[120:123]
    s_mov_b64 exec, -1
    s_waitcnt vmcnt(0)
    s_mov_b64 exec, 255
    buffer_store_dwordx4 v[20:23], v30, s[52:55], s83 offen sc1
    s_mov_b64 exec, -1
    s_add_u32 s79, s78, s9
    buffer_load_dwordx4 v[192:195], v30, s[52:55], s79 offen offset:0 sc1
    buffer_load_dwordx4 v[196:199], v30, s[52:55], s79 offen offset:1024 sc1
    buffer_load_dwordx4 v[200:203], v30, s[52:55], s79 offen offset:2048 sc1
    buffer_load_dwordx4 v[204:207], v30, s[52:55], s79 offen offset:3072 sc1
    s_add_u32 s9, s9, 4096
    s_cmp_eq_u32 s9, 28672
    s_cmov_b32 s9, 0
    s_setprio 1
L_post:
    s_cmp_eq_u32 s77, 1
    s_cbranch_scc1 L_conv1
L_conv0:
    ds_read_b64 v[32:33], v1 offset:3584
    ds_read_b64 v[34:35], v1 offset:3592
    ds_read_b64 v[36:37], v1 offset:2048
    ds_read_b64 v[38:39], v1 offset:2056
    ds_read_b64 v[40:41], v1 offset:0
    ds_read_b64 v[42:43], v1 offset:8
    ds_read_b64 v[44:45], v1 offset:1536
    ds_read_b64 v[46:47], v1 offset:1544
    ds_read_b64 v[48:49], v1 offset:3072
    ds_read_b64 v[50:51], v1 offset:3080
    s_waitcnt lgkmcnt(10)
    s_barrier
    ds_read_b128 v[52:55], v2 offset:3584
    ds_read_b128 v[72:75], v2 offset:2048
    ds_read_b128 v[76:79], v2 offset:0
    ds_read_b128 v[80:83], v2 offset:1536
    ds_read_b128 v[84:87], v2 offset:3072
    s_waitcnt lgkmcnt(4)
    v_mfma_f32_16x16x32_bf16 v[68:71], v[32:35], v[52:55], 0
    ds_read_b64 v[88:89], v1 offset:1024
    ds_read_b64 v[90:91], v1 offset:1032
    s_lshr_b32 s64, s75, 1
    s_mul_i32 s64, s64, 112
    v_mfma_f32_16x16x32_bf16 v[64:67], v[36:39], v[52:55], 0
    ds_read_b128 v[92:95], v2 offset:1024
    s_waitcnt lgkmcnt(6)
    v_mfma_f32_16x16x32_bf16 v[68:71], v[36:39], v[72:75], v[68:71]
    ds_read_b128 v[32:35], v2 offset:2560
    s_and_b32 s66, s75, 1
    s_add_u32 s64, s64, s66
    v_mfma_f32_16x16x32_bf16 v[56:59], v[40:43], v[52:55], 0
    ds_read_b64 v[36:37], v1 offset:2560
    ds_read_b64 v[38:39], v1 offset:2568
    s_mul_i32 s65, s60, 14
    s_add_u32 s64, s64, s65
    v_mfma_f32_16x16x32_bf16 v[60:63], v[40:43], v[72:75], 0
    s_add_u32 s79, s78, s9
    buffer_load_dwordx4 v[208:211], v30, s[52:55], s79 offen offset:0 sc1
    s_add_u32 s64, s64, 1792
    s_waitcnt lgkmcnt(8)
    v_mfma_f32_16x16x32_bf16 v[68:71], v[40:43], v[76:79], v[68:71]
    ds_read_b64 v[76:77], v1 offset:512
    ds_read_b64 v[78:79], v1 offset:520
    v_min_u32 v7, 6, v0
    v_lshl_add_u32 v7, v7, 1, s64
    v_mfma_f32_16x16x32_bf16 v[60:63], v[44:47], v[52:55], v[60:63]
    ds_read_b128 v[52:55], v2 offset:512
    buffer_load_dwordx4 v[212:215], v30, s[52:55], s79 offen offset:1024 sc1
    v_lshlrev_b32 v7, 7, v7
    s_waitcnt lgkmcnt(10)
    v_mfma_f32_16x16x32_bf16 v[64:67], v[40:43], v[80:83], v[64:67]
    ds_read_b64 v[40:41], v1 offset:3648
    ds_read_b64 v[42:43], v1 offset:3656
    s_lshr_b32 s65, s65, 1
    s_mul_i32 s64, s75, 224
    v_mfma_f32_16x16x32_bf16 v[68:71], v[44:47], v[80:83], v[68:71]
    ds_read_b128 v[80:83], v2 offset:3648
    buffer_load_dwordx4 v[216:219], v30, s[52:55], s79 offen offset:2048 sc1
    s_add_u32 s64, s64, s65
    s_waitcnt lgkmcnt(12)
    v_mfma_f32_16x16x32_bf16 v[64:67], v[44:47], v[84:87], v[64:67]
    ds_read_b64 v[44:45], v1 offset:2112
    ds_read_b64 v[46:47], v1 offset:2120
    s_lshl_b32 s64, s64, 10
    s_add_u32 s82, s64, 5505024
    v_mfma_f32_16x16x32_bf16 v[68:71], v[48:51], v[84:87], v[68:71]
    ds_read_b128 v[48:51], v2 offset:2112
    buffer_load_dwordx4 v[220:223], v30, s[52:55], s79 offen offset:3072 sc1
    s_add_u32 s9, s9, 4096
    s_cmp_eq_u32 s9, 28672
    s_cmov_b32 s9, 0
    s_add_u32 s66, s82, 7168
    s_waitcnt lgkmcnt(13)
    v_mfma_f32_16x16x32_bf16 v[60:63], v[88:91], v[84:87], v[60:63]
    ds_read_b64 v[84:85], v1 offset:64
    ds_read_b64 v[86:87], v1 offset:72
    s_and_b32 s59, s76, 2
    s_mul_i32 s72, s59, 57344
    s_waitcnt lgkmcnt(14)
    v_mfma_f32_16x16x32_bf16 v[68:71], v[88:91], v[92:95], v[68:71]
    ds_read_b128 v[92:95], v2 offset:64
    s_add_u32 s79, s78, s9
    buffer_load_dwordx4 v[224:227], v30, s[52:55], s79 offen offset:0 sc1
    v_add_u32 v21, s72, v30
    s_waitcnt lgkmcnt(14)
    v_mfma_f32_16x16x32_bf16 v[64:67], v[88:91], v[32:35], v[64:67]
    ds_read_b64 v[88:89], v1 offset:1600
    ds_read_b64 v[90:91], v1 offset:1608
    s_and_b32 s65, s75, 3
    s_lshl_b32 s65, s65, 2
    s_waitcnt lgkmcnt(14)
    v_mfma_f32_16x16x32_bf16 v[68:71], v[36:39], v[32:35], v[68:71]
    ds_read_b128 v[36:39], v2 offset:1600
    buffer_load_dwordx4 v[228:231], v30, s[52:55], s79 offen offset:1024 sc1
    s_lshr_b32 s65, 0x4040, s65
    s_waitcnt lgkmcnt(13)
    v_mfma_f32_16x16x32_bf16 v[60:63], v[76:79], v[32:35], v[60:63]
    ds_read_b128 v[32:35], v2 offset:3136
    s_and_b32 s65, s65, 7
    s_lshl_b32 s65, s65, 10
    s_setprio 0
    s_waitcnt lgkmcnt(13)
    v_mfma_f32_16x16x32_bf16 v[68:71], v[76:79], v[52:55], v[68:71]
    ds_read_b64 v[52:53], v1 offset:3136
    ds_read_b64 v[54:55], v1 offset:3144
    buffer_load_dwordx4 v[232:235], v30, s[52:55], s79 offen offset:2048 sc1
    s_add_u32 s4, s65, s82
    v_mfma_f32_16x16x32_bf16 v[64:67], v[76:79], v[72:75], v[64:67]
    ds_read_b64 v[76:77], v1 offset:1088
    ds_read_b64 v[78:79], v1 offset:1096
    s_add_u32 s5, s4, 1024
    s_cmp_eq_u32 s5, s66
    s_cmov_b32 s5, s82
    s_waitcnt lgkmcnt(14)
    v_mfma_f32_16x16x32_bf16 v[68:71], v[40:43], v[80:83], v[68:71]
    ds_read_b128 v[72:75], v2 offset:1088
    buffer_load_dwordx4 v[236:239], v30, s[52:55], s79 offen offset:3072 sc1
    s_add_u32 s9, s9, 4096
    s_cmp_eq_u32 s9, 28672
    s_cmov_b32 s9, 0
    s_add_u32 s6, s5, 1024
    s_waitcnt lgkmcnt(13)
    v_mfma_f32_16x16x32_bf16 v[64:67], v[44:47], v[80:83], v[64:67]
    ds_read_b128 v[40:43], v2 offset:2624
    s_cmp_eq_u32 s6, s66
    s_cmov_b32 s6, s82
    s_waitcnt lgkmcnt(13)
    v_mfma_f32_16x16x32_bf16 v[68:71], v[44:47], v[48:51], v[68:71]
    ds_read_b64 v[44:45], v1 offset:2624
    ds_read_b64 v[46:47], v1 offset:2632
    s_add_u32 s7, s6, 1024
    s_cmp_eq_u32 s7, s66
    s_cmov_b32 s7, s82
    s_add_u32 s8, s7, 1024
    s_cmp_eq_u32 s8, s66
    s_cmov_b32 s8, s82
    s_add_u32 s73, s8, 1024
    s_cmp_eq_u32 s73, s66
    s_cmov_b32 s73, s82
    s_add_u32 s74, s73, 1024
    s_cmp_eq_u32 s74, s66
    s_cmov_b32 s74, s82
    buffer_load_dword v22, v7, s[52:55], 0 offen offset:12 sc1
    s_waitcnt lgkmcnt(13)
    v_mfma_f32_16x16x32_bf16 v[56:59], v[84:87], v[80:83], v[56:59]
    v_lshrrev_b32 v4, 5, v0
    v_and_b32 v8, 15, v0
    v_mfma_f32_16x16x32_bf16 v[60:63], v[84:87], v[48:51], v[60:63]
    s_add_u32 s79, s78, s9
    buffer_load_dwordx4 v[240:243], v30, s[52:55], s79 offen offset:0 sc1
    v_lshrrev_b32 v9, 4, v0
    s_waitcnt lgkmcnt(12)
    v_mfma_f32_16x16x32_bf16 v[68:71], v[84:87], v[92:95], v[68:71]
    ds_read_b64 v[92:93], v1 offset:576
    ds_read_b64 v[94:95], v1 offset:584
    v_lshlrev_b32 v3, 5, v8
    v_lshl_or_b32 v27, v4, 12, v13
    s_waitcnt lgkmcnt(12)
    v_mfma_f32_16x16x32_bf16 v[60:63], v[88:91], v[80:83], v[60:63]
    ds_read_b128 v[80:83], v2 offset:576
    buffer_load_dwordx4 v[244:247], v30, s[52:55], s79 offen offset:1024 sc1
    s_lshl_b32 s64, s75, 3
    s_waitcnt lgkmcnt(12)
    v_mfma_f32_16x16x32_bf16 v[64:67], v[84:87], v[36:39], v[64:67]
    ds_read_b64 v[84:85], v1 offset:3712
    ds_read_b64 v[86:87], v1 offset:3720
    s_add_u32 s67, s64, s60
    s_lshl_b32 s65, s67, 5
    v_mfma_f32_16x16x32_bf16 v[68:71], v[88:91], v[36:39], v[68:71]
    ds_read_b128 v[36:39], v2 offset:3712
    buffer_load_dwordx4 v[248:251], v30, s[52:55], s79 offen offset:2048 sc1
    s_add_u32 s65, s65, 73728
    s_waitcnt lgkmcnt(14)
    v_mfma_f32_16x16x32_bf16 v[64:67], v[88:91], v[32:35], v[64:67]
    ds_read_b64 v[88:89], v1 offset:2176
    ds_read_b64 v[90:91], v1 offset:2184
    s_lshl_b32 s64, s67, 13
    s_lshl_b32 s3, s76, 7
    s_waitcnt lgkmcnt(14)
    v_mfma_f32_16x16x32_bf16 v[68:71], v[52:55], v[32:35], v[68:71]
    ds_read_b128 v[52:55], v2 offset:2176
    buffer_load_dwordx4 v[252:255], v30, s[52:55], s79 offen offset:3072 sc1
    s_add_u32 s94, s64, s3
    s_waitcnt lgkmcnt(13)
    v_mfma_f32_16x16x32_bf16 v[60:63], v[76:79], v[32:35], v[60:63]
    ds_read_b64 v[32:33], v1 offset:128
    ds_read_b64 v[34:35], v1 offset:136
    s_add_u32 s64, s59, 0
    s_and_b32 s64, s64, 3
    s_waitcnt lgkmcnt(14)
    v_mfma_f32_16x16x32_bf16 v[68:71], v[76:79], v[72:75], v[68:71]
    ds_read_b128 v[72:75], v2 offset:128
    s_lshl_b32 s64, s64, 10
    s_add_u32 s70, s64, s94
    s_waitcnt lgkmcnt(14)
    v_mfma_f32_16x16x32_bf16 v[64:67], v[76:79], v[40:43], v[64:67]
    ds_read_b64 v[76:77], v1 offset:1664
    ds_read_b64 v[78:79], v1 offset:1672
    s_add_u32 s64, s59, 1
    s_and_b32 s64, s64, 3
    s_waitcnt lgkmcnt(14)
    v_mfma_f32_16x16x32_bf16 v[68:71], v[44:47], v[40:43], v[68:71]
    ds_read_b128 v[44:47], v2 offset:1664
    s_lshl_b32 s64, s64, 10
    s_add_u32 s71, s64, s94
    s_waitcnt lgkmcnt(13)
    v_mfma_f32_16x16x32_bf16 v[60:63], v[92:95], v[40:43], v[60:63]
    ds_read_b128 v[40:43], v2 offset:3200
    s_add_u32 s64, s59, 2
    s_and_b32 s64, s64, 3
    s_waitcnt lgkmcnt(13)
    v_mfma_f32_16x16x32_bf16 v[68:71], v[92:95], v[80:83], v[68:71]
    ds_read_b64 v[80:81], v1 offset:3200
    ds_read_b64 v[82:83], v1 offset:3208
    s_lshl_b32 s64, s64, 10
    s_add_u32 s80, s64, s94
    v_mfma_f32_16x16x32_bf16 v[64:67], v[92:95], v[48:51], v[64:67]
    ds_read_b64 v[92:93], v1 offset:1152
    ds_read_b64 v[94:95], v1 offset:1160
    s_add_u32 s64, s59, 3
    s_and_b32 s64, s64, 3
    s_waitcnt lgkmcnt(14)
    v_mfma_f32_16x16x32_bf16 v[68:71], v[84:87], v[36:39], v[68:71]
    ds_read_b128 v[48:51], v2 offset:1152
    s_lshl_b32 s64, s64, 10
    s_add_u32 s81, s64, s94
    s_waitcnt lgkmcnt(13)
    v_mfma_f32_16x16x32_bf16 v[64:67], v[88:91], v[36:39], v[64:67]
    ds_read_b128 v[84:87], v2 offset:2688
    v_add_u32 v24, s59, v0
    v_and_b32 v24, 3, v24
    s_waitcnt lgkmcnt(13)
    v_mfma_f32_16x16x32_bf16 v[68:71], v[88:91], v[52:55], v[68:71]
    ds_read_b64 v[88:89], v1 offset:2688
    ds_read_b64 v[90:91], v1 offset:2696
    v_lshl_or_b32 v24, v4, 2, v24
    v_lshlrev_b32 v24, 2, v24
    s_waitcnt lgkmcnt(13)
    v_mfma_f32_16x16x32_bf16 v[56:59], v[32:35], v[36:39], v[56:59]
    buffer_load_dword v24, v24, s[52:55], s65 offen sc1
    s_lshl_b32 s64, s76, 3
    v_mfma_f32_16x16x32_bf16 v[60:63], v[32:35], v[52:55], v[60:63]
    s_add_u32 s64, s64, s60
    s_lshl_b32 s64, s64, 15
    s_waitcnt lgkmcnt(12)
    v_mfma_f32_16x16x32_bf16 v[68:71], v[32:35], v[72:75], v[68:71]
    ds_read_b64 v[72:73], v1 offset:640
    ds_read_b64 v[74:75], v1 offset:648
    s_lshl_b32 s65, s75, 8
    s_add_u32 s64, s64, s65
    s_waitcnt lgkmcnt(12)
    v_mfma_f32_16x16x32_bf16 v[60:63], v[76:79], v[36:39], v[60:63]
    ds_read_b128 v[36:39], v2 offset:640
    s_add_u32 s64, s64, 3407872
    s_add_u32 s65, s64, 13369344
    s_waitcnt lgkmcnt(12)
    v_mfma_f32_16x16x32_bf16 v[64:67], v[32:35], v[44:47], v[64:67]
    ds_read_b64 v[32:33], v1 offset:3776
    ds_read_b64 v[34:35], v1 offset:3784
    s_cmp_ge_u32 s59, 2
    s_cselect_b32 s89, s65, s64
    v_mfma_f32_16x16x32_bf16 v[68:71], v[76:79], v[44:47], v[68:71]
    ds_read_b128 v[44:47], v2 offset:3776
    s_waitcnt vmcnt(5)
    v_cmp_ne_u32 s[100:101], s63, v22
    s_nop 0
    s_cmp_lg_u64 s[100:101], 0
    s_cbranch_scc1 L_slow_30
L_back_31:
    s_waitcnt lgkmcnt(14)
    v_mfma_f32_16x16x32_bf16 v[64:67], v[76:79], v[40:43], v[64:67]
    ds_read_b64 v[76:77], v1 offset:2240
    ds_read_b64 v[78:79], v1 offset:2248
    buffer_load_dwordx4 v[96:99], v21, s[52:55], s4 offen sc1
    s_cmp_ge_u32 s59, 2
    s_cselect_b32 s90, s64, s65
    s_waitcnt lgkmcnt(14)
    v_mfma_f32_16x16x32_bf16 v[68:71], v[80:83], v[40:43], v[68:71]
    ds_read_b128 v[80:83], v2 offset:2240
    v_mul_u32_u24 v10, 272, v8
    v_lshlrev_b32 v8, 4, v8
    s_waitcnt lgkmcnt(13)
    v_mfma_f32_16x16x32_bf16 v[60:63], v[92:95], v[40:43], v[60:63]
    ds_read_b64 v[40:41], v1 offset:192
    ds_read_b64 v[42:43], v1 offset:200
    buffer_load_dwordx4 v[100:103], v21, s[52:55], s5 offen sc1
    v_lshl_add_u32 v12, s60, 2, v9
    s_waitcnt lgkmcnt(14)
    v_mfma_f32_16x16x32_bf16 v[68:71], v[92:95], v[48:51], v[68:71]
    ds_read_b128 v[48:51], v2 offset:192
    v_mul_u32_u24 v12, 272, v12
    v_add_u32 v12, v12, v8
    s_waitcnt lgkmcnt(14)
    v_mfma_f32_16x16x32_bf16 v[64:67], v[92:95], v[84:87], v[64:67]
    ds_read_b64 v[92:93], v1 offset:1728
    ds_read_b64 v[94:95], v1 offset:1736
    buffer_load_dwordx4 v[104:107], v21, s[52:55], s6 offen sc1
    v_lshl_or_b32 v8, v9, 13, v8
    s_waitcnt lgkmcnt(14)
    v_mfma_f32_16x16x32_bf16 v[68:71], v[88:91], v[84:87], v[68:71]
    ds_read_b128 v[88:91], v2 offset:1728
    s_lshl_b32 s64, s93, 1
    s_add_u32 s64, s64, s86
    s_waitcnt lgkmcnt(13)
    v_mfma_f32_16x16x32_bf16 v[60:63], v[72:75], v[84:87], v[60:63]
    ds_read_b128 v[84:87], v2 offset:3264
    buffer_load_dwordx4 v[108:111], v21, s[52:55], s7 offen sc1
    s_lshl_b32 s65, s77, 14
    s_waitcnt lgkmcnt(13)
    v_mfma_f32_16x16x32_bf16 v[68:71], v[72:75], v[36:39], v[68:71]
    ds_read_b64 v[36:37], v1 offset:3264
    ds_read_b64 v[38:39], v1 offset:3272
    s_add_u32 s65, s65, 81920
    s_lshl_b32 s66, s64, 10
    v_mfma_f32_16x16x32_bf16 v[64:67], v[72:75], v[52:55], v[64:67]
    ds_read_b64 v[72:73], v1 offset:1216
    ds_read_b64 v[74:75], v1 offset:1224
    buffer_load_dwordx4 v[112:115], v21, s[52:55], s8 offen sc1
    s_add_u32 s66, s66, s65
    s_waitcnt lgkmcnt(14)
    v_mfma_f32_16x16x32_bf16 v[68:71], v[32:35], v[44:47], v[68:71]
    ds_read_b128 v[52:55], v2 offset:1216
    v_add_u32 v5, s66, v30
    s_lshl_b32 s66, s64, 12
    s_waitcnt lgkmcnt(13)
    v_mfma_f32_16x16x32_bf16 v[64:67], v[76:79], v[44:47], v[64:67]
    ds_read_b128 v[32:35], v2 offset:2752
    buffer_load_dwordx4 v[116:119], v21, s[52:55], s73 offen sc1
    s_add_u32 s66, s66, s65
    s_waitcnt lgkmcnt(13)
    v_mfma_f32_16x16x32_bf16 v[68:71], v[76:79], v[80:83], v[68:71]
    ds_read_b64 v[76:77], v1 offset:2752
    ds_read_b64 v[78:79], v1 offset:2760
    v_add_u32 v6, s66, v30
    s_mul_i32 s64, s86, 3
    s_waitcnt lgkmcnt(13)
    v_mfma_f32_16x16x32_bf16 v[56:59], v[40:43], v[44:47], v[56:59]
    buffer_load_dwordx4 v[120:123], v21, s[52:55], s74 offen sc1
    s_add_u32 s72, s72, 57344
    s_cmp_eq_u32 s72, 229376
    s_cmov_b32 s72, 0
    v_add_u32 v21, s72, v30
    s_xor_b32 s64, s64, s77
    v_mfma_f32_16x16x32_bf16 v[60:63], v[40:43], v[80:83], v[60:63]
    s_lshl_b32 s65, s93, 2
    s_add_u32 s64, s64, s65
    s_waitcnt lgkmcnt(12)
    v_mfma_f32_16x16x32_bf16 v[68:71], v[40:43], v[48:51], v[68:71]
    ds_read_b64 v[48:49], v1 offset:704
    ds_read_b64 v[50:51], v1 offset:712
    buffer_load_dwordx4 v[124:127], v21, s[52:55], s4 offen sc1
    v_lshl_or_b32 v3, v9, 3, v3
    s_waitcnt lgkmcnt(12)
    v_mfma_f32_16x16x32_bf16 v[60:63], v[92:95], v[44:47], v[60:63]
    ds_read_b128 v[44:47], v2 offset:704
    s_lshl_b32 s65, s64, 9
    s_add_u32 s65, s65, 123936
    s_waitcnt lgkmcnt(12)
    v_mfma_f32_16x16x32_bf16 v[64:67], v[40:43], v[88:91], v[64:67]
    buffer_load_dwordx4 v[128:131], v21, s[52:55], s5 offen sc1
    v_add_u32 v16, s65, v3
    v_mfma_f32_16x16x32_bf16 v[68:71], v[92:95], v[88:91], v[68:71]
    v_lshlrev_b32 v26, 1, v3
    s_lshl_b32 s65, s58, 3
    s_waitcnt lgkmcnt(11)
    v_mfma_f32_16x16x32_bf16 v[64:67], v[92:95], v[84:87], v[64:67]
    buffer_load_dwordx4 v[132:135], v21, s[52:55], s6 offen sc1
    s_add_u32 s64, s64, s65
    s_waitcnt lgkmcnt(9)
    v_mfma_f32_16x16x32_bf16 v[68:71], v[36:39], v[84:87], v[68:71]
    s_lshl_b32 s64, s64, 10
    s_add_u32 s85, s64, 3407872
    s_waitcnt lgkmcnt(7)
    v_mfma_f32_16x16x32_bf16 v[60:63], v[72:75], v[84:87], v[60:63]
    buffer_load_dwordx4 v[136:139], v21, s[52:55], s7 offen sc1
    v_lshl_add_u32 v10, v9, 4, v10
    s_waitcnt lgkmcnt(6)
    v_mfma_f32_16x16x32_bf16 v[68:71], v[72:75], v[52:55], v[68:71]
    s_mul_i32 s66, s60, 4352
    s_add_u32 s66, s66, 16384
    s_waitcnt lgkmcnt(5)
    v_mfma_f32_16x16x32_bf16 v[64:67], v[72:75], v[32:35], v[64:67]
    buffer_load_dwordx4 v[140:143], v21, s[52:55], s8 offen sc1
    v_add_u32 v10, s66, v10
    s_waitcnt lgkmcnt(3)
    v_mfma_f32_16x16x32_bf16 v[68:71], v[76:79], v[32:35], v[68:71]
    v_lshl_add_u32 v9, s60, 1, v4
    v_mul_u32_u24 v11, 272, v9
    v_lshl_add_u32 v11, v13, 1, v11
    v_mul_u32_u24 v31, 68, v13
    v_lshl_add_u32 v31, v9, 4, v31
    ds_read_b64 v[18:19], v16 offset:16704
    ds_read_b64 v[16:17], v16
    s_waitcnt lgkmcnt(3)
    v_mfma_f32_16x16x32_bf16 v[60:63], v[48:51], v[32:35], v[60:63]
    s_waitcnt lgkmcnt(2)
    v_mfma_f32_16x16x32_bf16 v[68:71], v[48:51], v[44:47], v[68:71]
    v_mfma_f32_16x16x32_bf16 v[64:67], v[48:51], v[80:83], v[64:67]
    s_branch L_convdone
L_conv1:
    ds_read_b64 v[32:33], v1 offset:3072
    ds_read_b64 v[34:35], v1 offset:3080
    ds_read_b64 v[36:37], v1 offset:2560
    ds_read_b64 v[38:39], v1 offset:2568
    ds_read_b64 v[40:41], v1 offset:512
    ds_read_b64 v[42:43], v1 offset:520
    ds_read_b64 v[44:45], v1 offset:1024
    ds_read_b64 v[46:47], v1 offset:1032
    ds_read_b64 v[48:49], v1 offset:1536
    ds_read_b64 v[50:51], v1 offset:1544
    s_waitcnt lgkmcnt(10)
    s_barrier
    ds_read_b128 v[52:55], v2 offset:3584
    ds_read_b128 v[72:75], v2 offset:3072
    ds_read_b128 v[76:79], v2 offset:1536
    ds_read_b128 v[80:83], v2 offset:2048
    ds_read_b128 v[84:87], v2 offset:2560
    s_waitcnt lgkmcnt(4)
    v_mfma_f32_16x16x32_bf16 v[68:71], v[32:35], v[52:55], 0
    ds_read_b64 v[88:89], v1 offset:2048
    ds_read_b64 v[90:91], v1 offset:2056
    s_lshr_b32 s64, s75, 1
    s_mul_i32 s64, s64, 112
    v_mfma_f32_16x16x32_bf16 v[64:67], v[36:39], v[52:55], 0
    ds_read_b64 v[92:93], v1 offset:0
    ds_read_b64 v[94:95], v1 offset:8
    s_waitcnt lgkmcnt(7)
    v_mfma_f32_16x16x32_bf16 v[68:71], v[36:39], v[72:75], v[68:71]
    ds_read_b128 v[32:35], v2 offset:1024
    s_and_b32 s66, s75, 1
    s_add_u32 s64, s64, s66
    v_mfma_f32_16x16x32_bf16 v[56:59], v[40:43], v[52:55], 0
    ds_read_b128 v[36:39], v2 offset:512
    s_mul_i32 s65, s60, 14
    s_add_u32 s64, s64, s65
    v_mfma_f32_16x16x32_bf16 v[60:63], v[44:47], v[52:55], 0
    ds_read_b64 v[52:53], v1 offset:3136
    ds_read_b64 v[54:55], v1 offset:3144
    s_add_u32 s79, s78, s9
    buffer_load_dwordx4 v[208:211], v30, s[52:55], s79 offen offset:0 sc1
    s_add_u32 s64, s64, 1792
    s_waitcnt lgkmcnt(10)
    v_mfma_f32_16x16x32_bf16 v[64:67], v[40:43], v[76:79], v[64:67]
    v_min_u32 v7, 6, v0
    v_lshl_add_u32 v7, v7, 1, s64
    v_mfma_f32_16x16x32_bf16 v[68:71], v[44:47], v[76:79], v[68:71]
    ds_read_b128 v[76:79], v2 offset:3648
    buffer_load_dwordx4 v[212:215], v30, s[52:55], s79 offen offset:1024 sc1
    v_lshlrev_b32 v7, 7, v7
    v_mfma_f32_16x16x32_bf16 v[60:63], v[40:43], v[72:75], v[60:63]
    s_lshr_b32 s65, s65, 1
    s_mul_i32 s64, s75, 224
    s_waitcnt lgkmcnt(10)
    v_mfma_f32_16x16x32_bf16 v[64:67], v[44:47], v[80:83], v[64:67]
    ds_read_b64 v[44:45], v1 offset:2624
    ds_read_b64 v[46:47], v1 offset:2632
    buffer_load_dwordx4 v[216:219], v30, s[52:55], s79 offen offset:2048 sc1
    s_add_u32 s64, s64, s65
    v_mfma_f32_16x16x32_bf16 v[68:71], v[48:51], v[80:83], v[68:71]
    ds_read_b128 v[80:83], v2 offset:3136
    s_lshl_b32 s64, s64, 10
    s_add_u32 s82, s64, 5505024
    s_waitcnt lgkmcnt(12)
    v_mfma_f32_16x16x32_bf16 v[64:67], v[48:51], v[84:87], v[64:67]
    ds_read_b64 v[48:49], v1 offset:576
    ds_read_b64 v[50:51], v1 offset:584
    buffer_load_dwordx4 v[220:223], v30, s[52:55], s79 offen offset:3072 sc1
    s_add_u32 s9, s9, 4096
    s_cmp_eq_u32 s9, 28672
    s_cmov_b32 s9, 0
    s_add_u32 s66, s82, 7168
    s_waitcnt lgkmcnt(12)
    v_mfma_f32_16x16x32_bf16 v[68:71], v[88:91], v[84:87], v[68:71]
    s_and_b32 s59, s76, 2
    s_mul_i32 s72, s59, 57344
    v_mfma_f32_16x16x32_bf16 v[64:67], v[88:91], v[72:75], v[64:67]
    ds_read_b64 v[88:89], v1 offset:1088
    ds_read_b64 v[90:91], v1 offset:1096
    s_add_u32 s79, s78, s9
    buffer_load_dwordx4 v[224:227], v30, s[52:55], s79 offen offset:0 sc1
    v_add_u32 v21, s72, v30
    s_waitcnt lgkmcnt(12)
    v_mfma_f32_16x16x32_bf16 v[56:59], v[92:95], v[72:75], v[56:59]
    ds_read_b128 v[72:75], v2 offset:1600
    s_and_b32 s65, s75, 3
    s_lshl_b32 s65, s65, 2
    v_mfma_f32_16x16x32_bf16 v[60:63], v[92:95], v[84:87], v[60:63]
    ds_read_b128 v[84:87], v2 offset:2112
    buffer_load_dwordx4 v[228:231], v30, s[52:55], s79 offen offset:1024 sc1
    s_lshr_b32 s65, 0x4040, s65
    s_waitcnt lgkmcnt(13)
    v_mfma_f32_16x16x32_bf16 v[68:71], v[40:43], v[32:35], v[68:71]
    ds_read_b64 v[40:41], v1 offset:1600
    ds_read_b64 v[42:43], v1 offset:1608
    s_and_b32 s65, s65, 7
    s_lshl_b32 s65, s65, 10
    s_setprio 0
    v_mfma_f32_16x16x32_bf16 v[64:67], v[92:95], v[32:35], v[64:67]
    ds_read_b128 v[32:35], v2 offset:2624
    buffer_load_dwordx4 v[232:235], v30, s[52:55], s79 offen offset:2048 sc1
    s_add_u32 s4, s65, s82
    s_waitcnt lgkmcnt(15)
    v_mfma_f32_16x16x32_bf16 v[68:71], v[92:95], v[36:39], v[68:71]
    ds_read_b64 v[92:93], v1 offset:2112
    ds_read_b64 v[94:95], v1 offset:2120
    s_add_u32 s5, s4, 1024
    s_cmp_eq_u32 s5, s66
    s_cmov_b32 s5, s82
    s_waitcnt lgkmcnt(14)
    v_mfma_f32_16x16x32_bf16 v[68:71], v[52:55], v[76:79], v[68:71]
    ds_read_b64 v[36:37], v1 offset:64
    ds_read_b64 v[38:39], v1 offset:72
    buffer_load_dwordx4 v[236:239], v30, s[52:55], s79 offen offset:3072 sc1
    s_add_u32 s9, s9, 4096
    s_cmp_eq_u32 s9, 28672
    s_cmov_b32 s9, 0
    s_add_u32 s6, s5, 1024
    s_waitcnt lgkmcnt(14)
    v_mfma_f32_16x16x32_bf16 v[64:67], v[44:47], v[76:79], v[64:67]
    ds_read_b128 v[52:55], v2 offset:1088
    s_cmp_eq_u32 s6, s66
    s_cmov_b32 s6, s82
    s_waitcnt lgkmcnt(14)
    v_mfma_f32_16x16x32_bf16 v[68:71], v[44:47], v[80:83], v[68:71]
    ds_read_b128 v[44:47], v2 offset:576
    s_add_u32 s7, s6, 1024
    s_cmp_eq_u32 s7, s66
    s_cmov_b32 s7, s82
    s_add_u32 s8, s7, 1024
    s_cmp_eq_u32 s8, s66
    s_cmov_b32 s8, s82
    s_add_u32 s73, s8, 1024
    s_cmp_eq_u32 s73, s66
    s_cmov_b32 s73, s82
    s_add_u32 s74, s73, 1024
    s_cmp_eq_u32 s74, s66
    s_cmov_b32 s74, s82
    buffer_load_dword v22, v7, s[52:55], 0 offen offset:12 sc1
    s_waitcnt lgkmcnt(13)
    v_mfma_f32_16x16x32_bf16 v[56:59], v[48:51], v[76:79], v[56:59]
    v_lshrrev_b32 v4, 5, v0
    v_and_b32 v8, 15, v0
    s_waitcnt lgkmcnt(11)
    v_mfma_f32_16x16x32_bf16 v[60:63], v[88:91], v[76:79], v[60:63]
    ds_read_b64 v[76:77], v1 offset:3200
    ds_read_b64 v[78:79], v1 offset:3208
    s_add_u32 s79, s78, s9
    buffer_load_dwordx4 v[240:243], v30, s[52:55], s79 offen offset:0 sc1
    v_lshrrev_b32 v9, 4, v0
    s_waitcnt lgkmcnt(12)
    v_mfma_f32_16x16x32_bf16 v[64:67], v[48:51], v[72:75], v[64:67]
    v_lshlrev_b32 v3, 5, v8
    v_lshl_or_b32 v27, v4, 12, v13
    v_mfma_f32_16x16x32_bf16 v[68:71], v[88:91], v[72:75], v[68:71]
    ds_read_b128 v[72:75], v2 offset:3712
    buffer_load_dwordx4 v[244:247], v30, s[52:55], s79 offen offset:1024 sc1
    s_lshl_b32 s64, s75, 3
    v_mfma_f32_16x16x32_bf16 v[60:63], v[48:51], v[80:83], v[60:63]
    s_add_u32 s67, s64, s60
    s_lshl_b32 s65, s67, 5
    s_waitcnt lgkmcnt(12)
    v_mfma_f32_16x16x32_bf16 v[64:67], v[88:91], v[84:87], v[64:67]
    ds_read_b64 v[88:89], v1 offset:2688
    ds_read_b64 v[90:91], v1 offset:2696
    buffer_load_dwordx4 v[248:251], v30, s[52:55], s79 offen offset:2048 sc1
    s_add_u32 s65, s65, 73728
    s_waitcnt lgkmcnt(12)
    v_mfma_f32_16x16x32_bf16 v[68:71], v[40:43], v[84:87], v[68:71]
    ds_read_b128 v[84:87], v2 offset:3200
    s_lshl_b32 s64, s67, 13
    s_lshl_b32 s3, s76, 7
    s_waitcnt lgkmcnt(12)
    v_mfma_f32_16x16x32_bf16 v[64:67], v[40:43], v[32:35], v[64:67]
    ds_read_b64 v[40:41], v1 offset:640
    ds_read_b64 v[42:43], v1 offset:648
    buffer_load_dwordx4 v[252:255], v30, s[52:55], s79 offen offset:3072 sc1
    s_add_u32 s94, s64, s3
    s_waitcnt lgkmcnt(12)
    v_mfma_f32_16x16x32_bf16 v[68:71], v[92:95], v[32:35], v[68:71]
    s_add_u32 s64, s59, 0
    s_and_b32 s64, s64, 3
    v_mfma_f32_16x16x32_bf16 v[64:67], v[92:95], v[80:83], v[64:67]
    ds_read_b64 v[92:93], v1 offset:1152
    ds_read_b64 v[94:95], v1 offset:1160
    s_lshl_b32 s64, s64, 10
    s_add_u32 s70, s64, s94
    s_waitcnt lgkmcnt(12)
    v_mfma_f32_16x16x32_bf16 v[56:59], v[36:39], v[80:83], v[56:59]
    ds_read_b128 v[80:83], v2 offset:1664
    s_add_u32 s64, s59, 1
    s_and_b32 s64, s64, 3
    v_mfma_f32_16x16x32_bf16 v[60:63], v[36:39], v[32:35], v[60:63]
    ds_read_b128 v[32:35], v2 offset:2176
    s_lshl_b32 s64, s64, 10
    s_add_u32 s71, s64, s94
    s_waitcnt lgkmcnt(13)
    v_mfma_f32_16x16x32_bf16 v[68:71], v[48:51], v[52:55], v[68:71]
    ds_read_b64 v[48:49], v1 offset:1664
    ds_read_b64 v[50:51], v1 offset:1672
    s_add_u32 s64, s59, 2
    s_and_b32 s64, s64, 3
    v_mfma_f32_16x16x32_bf16 v[64:67], v[36:39], v[52:55], v[64:67]
    ds_read_b128 v[52:55], v2 offset:2688
    s_lshl_b32 s64, s64, 10
    s_add_u32 s80, s64, s94
    s_waitcnt lgkmcnt(15)
    v_mfma_f32_16x16x32_bf16 v[68:71], v[36:39], v[44:47], v[68:71]
    ds_read_b64 v[36:37], v1 offset:2176
    ds_read_b64 v[38:39], v1 offset:2184
    s_add_u32 s64, s59, 3
    s_and_b32 s64, s64, 3
    s_waitcnt lgkmcnt(14)
    v_mfma_f32_16x16x32_bf16 v[68:71], v[76:79], v[72:75], v[68:71]
    ds_read_b64 v[44:45], v1 offset:128
    ds_read_b64 v[46:47], v1 offset:136
    s_lshl_b32 s64, s64, 10
    s_add_u32 s81, s64, s94
    s_waitcnt lgkmcnt(14)
    v_mfma_f32_16x16x32_bf16 v[64:67], v[88:91], v[72:75], v[64:67]
    ds_read_b128 v[76:79], v2 offset:1152
    v_add_u32 v24, s59, v0
    v_and_b32 v24, 3, v24
    s_waitcnt lgkmcnt(14)
    v_mfma_f32_16x16x32_bf16 v[68:71], v[88:91], v[84:87], v[68:71]
    ds_read_b128 v[88:91], v2 offset:640
    v_lshl_or_b32 v24, v4, 2, v24
    v_lshlrev_b32 v24, 2, v24
    s_waitcnt lgkmcnt(13)
    v_mfma_f32_16x16x32_bf16 v[56:59], v[40:43], v[72:75], v[56:59]
    buffer_load_dword v24, v24, s[52:55], s65 offen sc1
    s_lshl_b32 s64, s76, 3
    s_waitcnt lgkmcnt(11)
    v_mfma_f32_16x16x32_bf16 v[60:63], v[92:95], v[72:75], v[60:63]
    ds_read_b64 v[72:73], v1 offset:3264
    ds_read_b64 v[74:75], v1 offset:3272
    s_add_u32 s64, s64, s60
    s_lshl_b32 s64, s64, 15
    s_waitcnt lgkmcnt(12)
    v_mfma_f32_16x16x32_bf16 v[64:67], v[40:43], v[80:83], v[64:67]
    s_lshl_b32 s65, s75, 8
    s_add_u32 s64, s64, s65
    v_mfma_f32_16x16x32_bf16 v[68:71], v[92:95], v[80:83], v[68:71]
    ds_read_b128 v[80:83], v2 offset:3776
    s_add_u32 s64, s64, 3407872
    s_add_u32 s65, s64, 13369344
    v_mfma_f32_16x16x32_bf16 v[60:63], v[40:43], v[84:87], v[60:63]
    s_cmp_ge_u32 s59, 2
    s_cselect_b32 s89, s65, s64
    s_waitcnt lgkmcnt(12)
    v_mfma_f32_16x16x32_bf16 v[64:67], v[92:95], v[32:35], v[64:67]
    ds_read_b64 v[92:93], v1 offset:2752
    ds_read_b64 v[94:95], v1 offset:2760
    s_waitcnt vmcnt(5)
    v_cmp_ne_u32 s[100:101], s63, v22
    s_nop 0
    s_cmp_lg_u64 s[100:101], 0
    s_cbranch_scc1 L_slow_33
L_back_34:
    s_waitcnt lgkmcnt(12)
    v_mfma_f32_16x16x32_bf16 v[68:71], v[48:51], v[32:35], v[68:71]
    ds_read_b128 v[32:35], v2 offset:3264
    buffer_load_dwordx4 v[96:99], v21, s[52:55], s4 offen sc1
    s_cmp_ge_u32 s59, 2
    s_cselect_b32 s90, s64, s65
    s_waitcnt lgkmcnt(12)
    v_mfma_f32_16x16x32_bf16 v[64:67], v[48:51], v[52:55], v[64:67]
    ds_read_b64 v[48:49], v1 offset:704
    ds_read_b64 v[50:51], v1 offset:712
    v_mul_u32_u24 v10, 272, v8
    v_lshlrev_b32 v8, 4, v8
    s_waitcnt lgkmcnt(12)
    v_mfma_f32_16x16x32_bf16 v[68:71], v[36:39], v[52:55], v[68:71]
    buffer_load_dwordx4 v[100:103], v21, s[52:55], s5 offen sc1
    v_lshl_add_u32 v12, s60, 2, v9
    v_mfma_f32_16x16x32_bf16 v[64:67], v[36:39], v[84:87], v[64:67]
    ds_read_b64 v[36:37], v1 offset:1216
    ds_read_b64 v[38:39], v1 offset:1224
    v_mul_u32_u24 v12, 272, v12
    v_add_u32 v12, v12, v8
    s_waitcnt lgkmcnt(12)
    v_mfma_f32_16x16x32_bf16 v[56:59], v[44:47], v[84:87], v[56:59]
    ds_read_b128 v[84:87], v2 offset:1728
    buffer_load_dwordx4 v[104:107], v21, s[52:55], s6 offen sc1
    v_lshl_or_b32 v8, v9, 13, v8
    v_mfma_f32_16x16x32_bf16 v[60:63], v[44:47], v[52:55], v[60:63]
    ds_read_b128 v[52:55], v2 offset:2240
    s_lshl_b32 s64, s93, 1
    s_add_u32 s64, s64, s86
    s_waitcnt lgkmcnt(13)
    v_mfma_f32_16x16x32_bf16 v[68:71], v[40:43], v[76:79], v[68:71]
    ds_read_b64 v[40:41], v1 offset:1728
    ds_read_b64 v[42:43], v1 offset:1736
    buffer_load_dwordx4 v[108:111], v21, s[52:55], s7 offen sc1
    s_lshl_b32 s65, s77, 14
    v_mfma_f32_16x16x32_bf16 v[64:67], v[44:47], v[76:79], v[64:67]
    ds_read_b128 v[76:79], v2 offset:2752
    s_add_u32 s65, s65, 81920
    s_lshl_b32 s66, s64, 10
    s_waitcnt lgkmcnt(15)
    v_mfma_f32_16x16x32_bf16 v[68:71], v[44:47], v[88:91], v[68:71]
    ds_read_b64 v[44:45], v1 offset:2240
    ds_read_b64 v[46:47], v1 offset:2248
    buffer_load_dwordx4 v[112:115], v21, s[52:55], s8 offen sc1
    s_add_u32 s66, s66, s65
    s_waitcnt lgkmcnt(14)
    v_mfma_f32_16x16x32_bf16 v[68:71], v[72:75], v[80:83], v[68:71]
    ds_read_b64 v[88:89], v1 offset:192
    ds_read_b64 v[90:91], v1 offset:200
    v_add_u32 v5, s66, v30
    s_lshl_b32 s66, s64, 12
    s_waitcnt lgkmcnt(14)
    v_mfma_f32_16x16x32_bf16 v[64:67], v[92:95], v[80:83], v[64:67]
    ds_read_b128 v[72:75], v2 offset:1216
    buffer_load_dwordx4 v[116:119], v21, s[52:55], s73 offen sc1
    s_add_u32 s66, s66, s65
    s_waitcnt lgkmcnt(14)
    v_mfma_f32_16x16x32_bf16 v[68:71], v[92:95], v[32:35], v[68:71]
    ds_read_b128 v[92:95], v2 offset:704
    v_add_u32 v6, s66, v30
    s_mul_i32 s64, s86, 3
    s_waitcnt lgkmcnt(13)
    v_mfma_f32_16x16x32_bf16 v[56:59], v[48:51], v[80:83], v[56:59]
    buffer_load_dwordx4 v[120:123], v21, s[52:55], s74 offen sc1
    s_add_u32 s72, s72, 57344
    s_cmp_eq_u32 s72, 229376
    s_cmov_b32 s72, 0
    v_add_u32 v21, s72, v30
    s_xor_b32 s64, s64, s77
    s_waitcnt lgkmcnt(11)
    v_mfma_f32_16x16x32_bf16 v[60:63], v[36:39], v[80:83], v[60:63]
    s_lshl_b32 s65, s93, 2
    s_add_u32 s64, s64, s65
    s_waitcnt lgkmcnt(10)
    v_mfma_f32_16x16x32_bf16 v[64:67], v[48:51], v[84:87], v[64:67]
    buffer_load_dwordx4 v[124:127], v21, s[52:55], s4 offen sc1
    v_lshl_or_b32 v3, v9, 3, v3
    v_mfma_f32_16x16x32_bf16 v[68:71], v[36:39], v[84:87], v[68:71]
    s_lshl_b32 s65, s64, 9
    s_add_u32 s65, s65, 123936
    v_mfma_f32_16x16x32_bf16 v[60:63], v[48:51], v[32:35], v[60:63]
    buffer_load_dwordx4 v[128:131], v21, s[52:55], s5 offen sc1
    v_add_u32 v16, s65, v3
    s_waitcnt lgkmcnt(9)
    v_mfma_f32_16x16x32_bf16 v[64:67], v[36:39], v[52:55], v[64:67]
    v_lshlrev_b32 v26, 1, v3
    s_lshl_b32 s65, s58, 3
    s_waitcnt lgkmcnt(7)
    v_mfma_f32_16x16x32_bf16 v[68:71], v[40:43], v[52:55], v[68:71]
    buffer_load_dwordx4 v[132:135], v21, s[52:55], s6 offen sc1
    s_add_u32 s64, s64, s65
    s_waitcnt lgkmcnt(6)
    v_mfma_f32_16x16x32_bf16 v[64:67], v[40:43], v[76:79], v[64:67]
    s_lshl_b32 s64, s64, 10
    s_add_u32 s85, s64, 3407872
    s_waitcnt lgkmcnt(4)
    v_mfma_f32_16x16x32_bf16 v[68:71], v[44:47], v[76:79], v[68:71]
    buffer_load_dwordx4 v[136:139], v21, s[52:55], s7 offen sc1
    v_lshl_add_u32 v10, v9, 4, v10
    v_mfma_f32_16x16x32_bf16 v[64:67], v[44:47], v[32:35], v[64:67]
    s_mul_i32 s66, s60, 4352
    s_add_u32 s66, s66, 16384
    s_waitcnt lgkmcnt(2)
    v_mfma_f32_16x16x32_bf16 v[56:59], v[88:91], v[32:35], v[56:59]
    buffer_load_dwordx4 v[140:143], v21, s[52:55], s8 offen sc1
    v_add_u32 v10, s66, v10
    v_mfma_f32_16x16x32_bf16 v[60:63], v[88:91], v[76:79], v[60:63]
    v_lshl_add_u32 v9, s60, 1, v4
    v_mul_u32_u24 v11, 272, v9
    v_lshl_add_u32 v11, v13, 1, v11
    v_mul_u32_u24 v31, 68, v13
    v_lshl_add_u32 v31, v9, 4, v31
    ds_read_b64 v[18:19], v16 offset:16704
    ds_read_b64 v[16:17], v16
    s_waitcnt lgkmcnt(3)
    v_mfma_f32_16x16x32_bf16 v[68:71], v[48:51], v[72:75], v[68:71]
    v_mfma_f32_16x16x32_bf16 v[64:67], v[88:91], v[72:75], v[64:67]
    s_waitcnt lgkmcnt(2)
    v_mfma_f32_16x16x32_bf16 v[68:71], v[88:91], v[92:95], v[68:71]
L_convdone:
    s_waitcnt vmcnt(11)
    v_mfma_f32_16x16x32_bf16 v[72:75], v[144:147], v[96:99], 0
    s_waitcnt lgkmcnt(0)
    v_lshlrev_b32 v88, 16, v16
    v_mfma_f32_16x16x32_bf16 v[76:79], v[148:151], v[96:99], 0
    v_and_b32 v89, s88, v16
    v_mfma_f32_16x16x32_bf16 v[80:83], v[152:155], v[96:99], 0
    v_lshlrev_b32 v90, 16, v17
    v_mfma_f32_16x16x32_bf16 v[84:87], v[156:159], v[96:99], 0
    buffer_load_dwordx4 v[96:99], v21, s[52:55], s73 offen sc1
    ds_write_b128 v5, v[56:59] offset:0
    v_and_b32 v91, s88, v17
    s_waitcnt vmcnt(11)
    v_mfma_f32_16x16x32_bf16 v[72:75], v[160:163], v[100:103], v[72:75]
    ds_write_b128 v5, v[60:63] offset:4096
    v_lshlrev_b32 v92, 16, v18
    v_mfma_f32_16x16x32_bf16 v[76:79], v[164:167], v[100:103], v[76:79]
    buffer_load_dword v28, v27, s[36:39], s70 offen
    ds_write_b128 v5, v[64:67] offset:8192
    v_and_b32 v93, s88, v18
    v_mfma_f32_16x16x32_bf16 v[80:83], v[168:171], v[100:103], v[80:83]
    ds_write_b128 v5, v[68:71] offset:12288
    v_lshlrev_b32 v94, 16, v19
    v_mfma_f32_16x16x32_bf16 v[84:87], v[172:175], v[100:103], v[84:87]
    buffer_load_dwordx4 v[100:103], v21, s[52:55], s74 offen sc1
    s_add_u32 s72, s72, 57344
    s_cmp_eq_u32 s72, 229376
    s_cmov_b32 s72, 0
    v_add_u32 v21, s72, v30
    v_and_b32 v95, s88, v19
    s_waitcnt vmcnt(12)
    v_mfma_f32_16x16x32_bf16 v[72:75], v[176:179], v[104:107], v[72:75]
    s_waitcnt lgkmcnt(0)
    s_barrier
    s_or_b32 s3, s2, s60
    s_cbranch_scc1 L_cnt_36
    buffer_store_dword v23, v13, s[52:55], 0 offen sc1
L_cnt_36:
    ds_read_b128 v[32:35], v6 offset:0
    ds_read_b128 v[40:43], v6 offset:2048
    v_mfma_f32_16x16x32_bf16 v[76:79], v[180:183], v[104:107], v[76:79]
    buffer_load_dword v29, v27, s[36:39], s71 offen
    ds_read_b128 v[36:39], v6 offset:1024
    ds_read_b128 v[44:47], v6 offset:3072
    v_mfma_f32_16x16x32_bf16 v[80:83], v[184:187], v[104:107], v[80:83]
    v_mfma_f32_16x16x32_bf16 v[84:87], v[188:191], v[104:107], v[84:87]
    buffer_load_dwordx4 v[104:107], v21, s[52:55], s4 offen sc1
    s_waitcnt vmcnt(13)
    v_mfma_f32_16x16x32_bf16 v[72:75], v[192:195], v[108:111], v[72:75]
    s_waitcnt lgkmcnt(3)
    v_fmac_f32 v32, s57, v88
    v_fmac_f32 v33, s57, v89
    v_fmac_f32 v34, s57, v90
    v_mfma_f32_16x16x32_bf16 v[76:79], v[196:199], v[108:111], v[76:79]
    buffer_load_dword v14, v27, s[36:39], s80 offen
    v_fmac_f32 v35, s57, v91
    s_waitcnt lgkmcnt(2)
    v_add_f32 v32, v32, v40
    v_add_f32 v33, v33, v41
    v_mfma_f32_16x16x32_bf16 v[80:83], v[200:203], v[108:111], v[80:83]
    v_add_f32 v34, v34, v42
    v_add_f32 v35, v35, v43
    s_waitcnt lgkmcnt(1)
    v_fmac_f32 v36, s68, v92
    v_mfma_f32_16x16x32_bf16 v[84:87], v[204:207], v[108:111], v[84:87]
    buffer_load_dwordx4 v[108:111], v21, s[52:55], s5 offen sc1
    v_fmac_f32 v37, s68, v93
    v_fmac_f32 v38, s68, v94
    v_fmac_f32 v39, s68, v95
    s_waitcnt vmcnt(14)
    v_mfma_f32_16x16x32_bf16 v[72:75], v[208:211], v[112:115], v[72:75]
    s_waitcnt lgkmcnt(0)
    v_add_f32 v36, v36, v44
    v_add_f32 v37, v37, v45
    v_add_f32 v38, v38, v46
    v_mfma_f32_16x16x32_bf16 v[76:79], v[212:215], v[112:115], v[76:79]
    buffer_load_dword v25, v27, s[36:39], s81 offen
    v_add_f32 v39, v39, v47
    v_cvt_pk_bf16_f32 v88, v32, v36
    v_cvt_pk_bf16_f32 v89, v33, v37
    v_mfma_f32_16x16x32_bf16 v[80:83], v[216:219], v[112:115], v[80:83]
    v_cvt_pk_bf16_f32 v92, v34, v38
    v_cvt_pk_bf16_f32 v93, v35, v39
    v_mov_b32 v90, s63
    v_mfma_f32_16x16x32_bf16 v[84:87], v[220:223], v[112:115], v[84:87]
    buffer_load_dwordx4 v[112:115], v21, s[52:55], s6 offen sc1
    v_mov_b32 v94, s63
    s_waitcnt vmcnt(15)
    v_mfma_f32_16x16x32_bf16 v[72:75], v[224:227], v[116:119], v[72:75]
    buffer_store_dwordx4 v[88:91], v26, s[52:55], s85 offen sc1
    s_add_u32 s85, s85, 13369344
    v_mfma_f32_16x16x32_bf16 v[76:79], v[228:231], v[116:119], v[76:79]
    buffer_store_dwordx4 v[92:95], v26, s[52:55], s85 offen sc1
    v_mfma_f32_16x16x32_bf16 v[80:83], v[232:235], v[116:119], v[80:83]
    v_mfma_f32_16x16x32_bf16 v[84:87], v[236:239], v[116:119], v[84:87]
    s_waitcnt vmcnt(16)
    v_mfma_f32_16x16x32_bf16 v[72:75], v[240:243], v[120:123], v[72:75]
    v_mfma_f32_16x16x32_bf16 v[76:79], v[244:247], v[120:123], v[76:79]
    v_mfma_f32_16x16x32_bf16 v[80:83], v[248:251], v[120:123], v[80:83]
    v_mfma_f32_16x16x32_bf16 v[84:87], v[252:255], v[120:123], v[84:87]
    s_waitcnt vmcnt(15)
    v_mfma_f32_16x16x32_bf16 v[56:59], v[144:147], v[124:127], 0
    v_mfma_f32_16x16x32_bf16 v[60:63], v[148:151], v[124:127], 0
    ds_write_b128 v10, v[72:75] offset:0
    v_mfma_f32_16x16x32_bf16 v[64:67], v[152:155], v[124:127], 0
    v_mfma_f32_16x16x32_bf16 v[68:71], v[156:159], v[124:127], 0
    ds_write_b128 v10, v[76:79] offset:64
    s_waitcnt vmcnt(14)
    v_mfma_f32_16x16x32_bf16 v[56:59], v[160:163], v[128:131], v[56:59]
    v_mfma_f32_16x16x32_bf16 v[60:63], v[164:167], v[128:131], v[60:63]
    ds_write_b128 v10, v[80:83] offset:128
    v_mfma_f32_16x16x32_bf16 v[64:67], v[168:171], v[128:131], v[64:67]
    v_mfma_f32_16x16x32_bf16 v[68:71], v[172:175], v[128:131], v[68:71]
    ds_write_b128 v10, v[84:87] offset:192
    s_waitcnt vmcnt(13)
    v_mfma_f32_16x16x32_bf16 v[56:59], v[176:179], v[132:135], v[56:59]
    v_mfma_f32_16x16x32_bf16 v[60:63], v[180:183], v[132:135], v[60:63]
    v_mfma_f32_16x16x32_bf16 v[64:67], v[184:187], v[132:135], v[64:67]
    v_mfma_f32_16x16x32_bf16 v[68:71], v[188:191], v[132:135], v[68:71]
    s_waitcnt vmcnt(12)
    v_mfma_f32_16x16x32_bf16 v[56:59], v[192:195], v[136:139], v[56:59]
    s_waitcnt lgkmcnt(0)
    s_barrier
    ds_read_b64 v[40:41], v11 offset:16384
    ds_read_b64 v[42:43], v11 offset:20736
    v_mfma_f32_16x16x32_bf16 v[60:63], v[196:199], v[136:139], v[60:63]
    ds_read_b64 v[44:45], v11 offset:25088
    ds_read_b64 v[46:47], v11 offset:29440
    v_mfma_f32_16x16x32_bf16 v[64:67], v[200:203], v[136:139], v[64:67]
    ds_read_b64 v[48:49], v11 offset:33792
    ds_read_b64 v[50:51], v11 offset:38144
    v_mfma_f32_16x16x32_bf16 v[68:71], v[204:207], v[136:139], v[68:71]
    ds_read_b64 v[52:53], v11 offset:42496
    ds_read_b64 v[54:55], v11 offset:46848
    s_waitcnt vmcnt(11)
    v_mfma_f32_16x16x32_bf16 v[56:59], v[208:211], v[140:143], v[56:59]
    v_mfma_f32_16x16x32_bf16 v[60:63], v[212:215], v[140:143], v[60:63]
    v_mfma_f32_16x16x32_bf16 v[64:67], v[216:219], v[140:143], v[64:67]
    buffer_load_dwordx4 v[116:119], v21, s[52:55], s7 offen sc1
    v_mfma_f32_16x16x32_bf16 v[68:71], v[220:223], v[140:143], v[68:71]
    s_waitcnt vmcnt(10)
    v_lshlrev_b32 v32, 16, v28
    v_and_b32 v33, s88, v28
    v_mfma_f32_16x16x32_bf16 v[56:59], v[224:227], v[96:99], v[56:59]
    s_waitcnt lgkmcnt(3)
    v_add_f32 v40, v40, v48
    v_add_f32 v41, v41, v49
    v_mfma_f32_16x16x32_bf16 v[60:63], v[228:231], v[96:99], v[60:63]
    s_waitcnt lgkmcnt(2)
    v_add_f32 v42, v42, v50
    v_add_f32 v43, v43, v51
    v_mfma_f32_16x16x32_bf16 v[64:67], v[232:235], v[96:99], v[64:67]
    buffer_load_dwordx4 v[120:123], v21, s[52:55], s8 offen sc1
    s_waitcnt lgkmcnt(1)
    v_add_f32 v44, v44, v52
    v_add_f32 v45, v45, v53
    v_mfma_f32_16x16x32_bf16 v[68:71], v[236:239], v[96:99], v[68:71]
    s_waitcnt lgkmcnt(0)
    v_add_f32 v46, v46, v54
    v_add_f32 v47, v47, v55
    s_waitcnt vmcnt(10)
    v_mfma_f32_16x16x32_bf16 v[56:59], v[240:243], v[100:103], v[56:59]
    v_add_f32 v40, v40, v44
    v_add_f32 v41, v41, v45
    v_mfma_f32_16x16x32_bf16 v[60:63], v[244:247], v[100:103], v[60:63]
    v_add_f32 v42, v42, v46
    v_add_f32 v43, v43, v47
    v_mfma_f32_16x16x32_bf16 v[64:67], v[248:251], v[100:103], v[64:67]
    buffer_load_dwordx4 v[124:127], v21, s[52:55], s73 offen sc1
    v_add_f32 v40, v40, v42
    v_add_f32 v41, v41, v43
    v_mfma_f32_16x16x32_bf16 v[68:71], v[252:255], v[100:103], v[68:71]
    v_fmac_f32_dpp v32, v24, v40 quad_perm:[0,0,0,0] row_mask:0xf bank_mask:0xf
    v_fmac_f32_dpp v33, v24, v41 quad_perm:[0,0,0,0] row_mask:0xf bank_mask:0xf
    s_waitcnt vmcnt(9)
    v_mfma_f32_16x16x32_bf16 v[72:75], v[144:147], v[104:107], 0
    v_mfma_f32_16x16x32_bf16 v[76:79], v[148:151], v[104:107], 0
    v_add_u32 v10, 34816, v10
    ds_write_b128 v10, v[56:59] offset:0
    v_mfma_f32_16x16x32_bf16 v[80:83], v[152:155], v[104:107], 0
    buffer_load_dwordx4 v[128:131], v21, s[52:55], s74 offen sc1
    s_add_u32 s72, s72, 57344
    s_cmp_eq_u32 s72, 229376
    s_cmov_b32 s72, 0
    v_add_u32 v21, s72, v30
    v_mfma_f32_16x16x32_bf16 v[84:87], v[156:159], v[104:107], 0
    ds_write_b128 v10, v[60:63] offset:64
    s_waitcnt vmcnt(8)
    v_mfma_f32_16x16x32_bf16 v[72:75], v[160:163], v[108:111], v[72:75]
    v_mfma_f32_16x16x32_bf16 v[76:79], v[164:167], v[108:111], v[76:79]
    ds_write_b128 v10, v[64:67] offset:128
    v_mfma_f32_16x16x32_bf16 v[80:83], v[168:171], v[108:111], v[80:83]
    buffer_load_dwordx4 v[132:135], v21, s[52:55], s4 offen sc1
    v_mfma_f32_16x16x32_bf16 v[84:87], v[172:175], v[108:111], v[84:87]
    ds_write_b128 v10, v[68:71] offset:192
    s_waitcnt vmcnt(7)
    v_mfma_f32_16x16x32_bf16 v[72:75], v[176:179], v[112:115], v[72:75]
    v_mfma_f32_16x16x32_bf16 v[76:79], v[180:183], v[112:115], v[76:79]
    v_mfma_f32_16x16x32_bf16 v[80:83], v[184:187], v[112:115], v[80:83]
    buffer_load_dwordx4 v[136:139], v21, s[52:55], s5 offen sc1
    v_mfma_f32_16x16x32_bf16 v[84:87], v[188:191], v[112:115], v[84:87]
    s_waitcnt vmcnt(5)
    v_mfma_f32_16x16x32_bf16 v[72:75], v[192:195], v[116:119], v[72:75]
    s_waitcnt lgkmcnt(0)
    s_barrier
    v_add_u32 v11, 34816, v11
    ds_read_b64 v[40:41], v11 offset:16384
    ds_read_b64 v[42:43], v11 offset:20736
    v_mfma_f32_16x16x32_bf16 v[76:79], v[196:199], v[116:119], v[76:79]
    ds_read_b64 v[44:45], v11 offset:25088
    ds_read_b64 v[46:47], v11 offset:29440
    v_mfma_f32_16x16x32_bf16 v[80:83], v[200:203], v[116:119], v[80:83]
    buffer_load_dwordx4 v[140:143], v21, s[52:55], s6 offen sc1
    ds_read_b64 v[48:49], v11 offset:33792
    ds_read_b64 v[50:51], v11 offset:38144
    v_mfma_f32_16x16x32_bf16 v[84:87], v[204:207], v[116:119], v[84:87]
    ds_read_b64 v[52:53], v11 offset:42496
    ds_read_b64 v[54:55], v11 offset:46848
    s_waitcnt vmcnt(5)
    v_mfma_f32_16x16x32_bf16 v[72:75], v[208:211], v[120:123], v[72:75]
    v_mfma_f32_16x16x32_bf16 v[76:79], v[212:215], v[120:123], v[76:79]
    v_mfma_f32_16x16x32_bf16 v[80:83], v[216:219], v[120:123], v[80:83]
    buffer_load_dwordx4 v[96:99], v21, s[52:55], s7 offen sc1
    v_mfma_f32_16x16x32_bf16 v[84:87], v[220:223], v[120:123], v[84:87]
    v_lshlrev_b32 v34, 16, v29
    v_and_b32 v35, s88, v29
    s_waitcnt vmcnt(5)
    v_mfma_f32_16x16x32_bf16 v[72:75], v[224:227], v[124:127], v[72:75]
    s_waitcnt lgkmcnt(3)
    v_add_f32 v40, v40, v48
    v_add_f32 v41, v41, v49
    v_mfma_f32_16x16x32_bf16 v[76:79], v[228:231], v[124:127], v[76:79]
    s_waitcnt lgkmcnt(2)
    v_add_f32 v42, v42, v50
    v_add_f32 v43, v43, v51
    v_mfma_f32_16x16x32_bf16 v[80:83], v[232:235], v[124:127], v[80:83]
    buffer_load_dwordx4 v[100:103], v21, s[52:55], s8 offen sc1
    s_waitcnt lgkmcnt(1)
    v_add_f32 v44, v44, v52
    v_add_f32 v45, v45, v53
    v_mfma_f32_16x16x32_bf16 v[84:87], v[236:239], v[124:127], v[84:87]
    s_waitcnt lgkmcnt(0)
    v_add_f32 v46, v46, v54
    v_add_f32 v47, v47, v55
    s_waitcnt vmcnt(5)
    v_mfma_f32_16x16x32_bf16 v[72:75], v[240:243], v[128:131], v[72:75]
    v_add_f32 v40, v40, v44
    v_add_f32 v41, v41, v45
    v_mfma_f32_16x16x32_bf16 v[76:79], v[244:247], v[128:131], v[76:79]
    v_add_f32 v42, v42, v46
    v_add_f32 v43, v43, v47
    v_mfma_f32_16x16x32_bf16 v[80:83], v[248:251], v[128:131], v[80:83]
    buffer_load_dwordx4 v[104:107], v21, s[52:55], s73 offen sc1
    v_add_f32 v40, v40, v42
    v_add_f32 v41, v41, v43
    v_mfma_f32_16x16x32_bf16 v[84:87], v[252:255], v[128:131], v[84:87]
    v_fmac_f32_dpp v34, v24, v40 quad_perm:[1,1,1,1] row_mask:0xf bank_mask:0xf
    v_fmac_f32_dpp v35, v24, v41 quad_perm:[1,1,1,1] row_mask:0xf bank_mask:0xf
    s_waitcnt vmcnt(5)
    v_mfma_f32_16x16x32_bf16 v[56:59], v[144:147], v[132:135], 0
    v_mfma_f32_16x16x32_bf16 v[60:63], v[148:151], v[132:135], 0
    v_add_u32 v10, 34816, v10
    ds_write_b128 v10, v[72:75] offset:0
    v_mfma_f32_16x16x32_bf16 v[64:67], v[152:155], v[132:135], 0
    buffer_load_dwordx4 v[108:111], v21, s[52:55], s74 offen sc1
    v_mfma_f32_16x16x32_bf16 v[68:71], v[156:159], v[132:135], 0
    ds_write_b128 v10, v[76:79] offset:64
    s_waitcnt vmcnt(5)
    v_mfma_f32_16x16x32_bf16 v[56:59], v[160:163], v[136:139], v[56:59]
    v_mfma_f32_16x16x32_bf16 v[60:63], v[164:167], v[136:139], v[60:63]
    ds_write_b128 v10, v[80:83] offset:128
    v_mfma_f32_16x16x32_bf16 v[64:67], v[168:171], v[136:139], v[64:67]
    buffer_load_dwordx4 v[16:19], v8, s[52:55], s89 offen sc1
    v_mfma_f32_16x16x32_bf16 v[68:71], v[172:175], v[136:139], v[68:71]
    ds_write_b128 v10, v[84:87] offset:192
    s_waitcnt vmcnt(5)
    v_mfma_f32_16x16x32_bf16 v[56:59], v[176:179], v[140:143], v[56:59]
    buffer_load_dwordx4 v[4:7], v8, s[52:55], s90 offen sc1
    v_mfma_f32_16x16x32_bf16 v[60:63], v[180:183], v[140:143], v[60:63]
    v_mfma_f32_16x16x32_bf16 v[64:67], v[184:187], v[140:143], v[64:67]
    v_mfma_f32_16x16x32_bf16 v[68:71], v[188:191], v[140:143], v[68:71]
    s_waitcnt vmcnt(5)
    v_mfma_f32_16x16x32_bf16 v[56:59], v[192:195], v[96:99], v[56:59]
    s_waitcnt lgkmcnt(0)
    s_barrier
    v_add_u32 v11, 34816, v11
    ds_read_b64 v[40:41], v11 offset:16384
    ds_read_b64 v[42:43], v11 offset:20736
    v_mfma_f32_16x16x32_bf16 v[60:63], v[196:199], v[96:99], v[60:63]
    ds_read_b64 v[44:45], v11 offset:25088
    ds_read_b64 v[46:47], v11 offset:29440
    v_mfma_f32_16x16x32_bf16 v[64:67], v[200:203], v[96:99], v[64:67]
    ds_read_b64 v[48:49], v11 offset:33792
    ds_read_b64 v[50:51], v11 offset:38144
    v_mfma_f32_16x16x32_bf16 v[68:71], v[204:207], v[96:99], v[68:71]
    ds_read_b64 v[52:53], v11 offset:42496
    ds_read_b64 v[54:55], v11 offset:46848
    s_waitcnt vmcnt(4)
    v_mfma_f32_16x16x32_bf16 v[56:59], v[208:211], v[100:103], v[56:59]
    s_waitcnt vmcnt(3)
    v_mfma_f32_16x16x32_bf16 v[56:59], v[224:227], v[104:107], v[56:59]
    s_waitcnt vmcnt(2)
    v_mfma_f32_16x16x32_bf16 v[56:59], v[240:243], v[108:111], v[56:59]
    v_mfma_f32_16x16x32_bf16 v[60:63], v[212:215], v[100:103], v[60:63]
    v_lshlrev_b32 v36, 16, v14
    v_and_b32 v37, s88, v14
    v_mfma_f32_16x16x32_bf16 v[60:63], v[228:231], v[104:107], v[60:63]
    s_waitcnt lgkmcnt(3)
    v_add_f32 v40, v40, v48
    v_add_f32 v41, v41, v49
    v_add_u32 v10, 34816, v10
    ds_write_b128 v10, v[56:59] offset:0
    v_lshlrev_b32 v38, 16, v25
    v_and_b32 v39, s88, v25
    v_mfma_f32_16x16x32_bf16 v[60:63], v[244:247], v[108:111], v[60:63]
    s_waitcnt lgkmcnt(3)
    v_add_f32 v42, v42, v50
    v_add_f32 v43, v43, v51
    v_mfma_f32_16x16x32_bf16 v[64:67], v[216:219], v[100:103], v[64:67]
    s_waitcnt lgkmcnt(2)
    v_add_f32 v44, v44, v52
    v_add_f32 v45, v45, v53
    v_mfma_f32_16x16x32_bf16 v[64:67], v[232:235], v[104:107], v[64:67]
    s_waitcnt lgkmcnt(1)
    v_add_f32 v46, v46, v54
    v_add_f32 v47, v47, v55
    ds_write_b128 v10, v[60:63] offset:64
    v_mfma_f32_16x16x32_bf16 v[64:67], v[248:251], v[108:111], v[64:67]
    v_add_f32 v40, v40, v44
    v_add_f32 v41, v41, v45
    v_mfma_f32_16x16x32_bf16 v[68:71], v[220:223], v[100:103], v[68:71]
    v_add_f32 v42, v42, v46
    v_add_f32 v43, v43, v47
    v_mfma_f32_16x16x32_bf16 v[68:71], v[236:239], v[104:107], v[68:71]
    s_waitcnt vmcnt(1)
    v_xor_b32 v18, s63, v18
    s_waitcnt vmcnt(0)
    v_xor_b32 v6, s63, v6
    v_or_b32 v18, v18, v6
    v_cmp_ne_u32 s[100:101], 0, v18
    s_nop 0
    s_cmp_lg_u64 s[100:101], 0
    s_cbranch_scc1 L_slow_37
L_back_38:
    ds_write2_b64 v12, v[16:17], v[4:5] offset0:0 offset1:1
    v_add_f32 v40, v40, v42
    v_add_f32 v41, v41, v43
    ds_write_b128 v10, v[64:67] offset:128
    v_mfma_f32_16x16x32_bf16 v[68:71], v[252:255], v[108:111], v[68:71]
    v_fmac_f32_dpp v36, v24, v40 quad_perm:[2,2,2,2] row_mask:0xf bank_mask:0xf
    v_fmac_f32_dpp v37, v24, v41 quad_perm:[2,2,2,2] row_mask:0xf bank_mask:0xf
    s_nop 5
    ds_write_b128 v10, v[68:71] offset:192
    s_waitcnt lgkmcnt(0)
    s_barrier
    ds_read_b128 v[16:19], v31 offset:0
    v_add_u32 v11, 34816, v11
    ds_read_b64 v[40:41], v11 offset:16384
    ds_read_b64 v[42:43], v11 offset:20736
    ds_read_b64 v[44:45], v11 offset:25088
    ds_read_b64 v[46:47], v11 offset:29440
    ds_read_b64 v[48:49], v11 offset:33792
    ds_read_b64 v[50:51], v11 offset:38144
    ds_read_b64 v[52:53], v11 offset:42496
    ds_read_b64 v[54:55], v11 offset:46848
    s_waitcnt lgkmcnt(8)
    v_lshlrev_b32 v20, 16, v16
    v_and_b32 v21, s88, v16
    v_pk_add_f32 v[20:21], v[20:21], v[32:33]
    v_cvt_pk_bf16_f32 v16, v20, v21
    buffer_store_dword v16, v27, s[48:51], s70 offen sc0 sc1
    v_lshlrev_b32 v22, 16, v17
    v_and_b32 v23, s88, v17
    v_pk_add_f32 v[22:23], v[22:23], v[34:35]
    v_cvt_pk_bf16_f32 v17, v22, v23
    buffer_store_dword v17, v27, s[48:51], s71 offen sc0 sc1
    v_lshlrev_b32 v20, 16, v18
    v_and_b32 v21, s88, v18
    v_pk_add_f32 v[20:21], v[20:21], v[36:37]
    v_cvt_pk_bf16_f32 v18, v20, v21
    buffer_store_dword v18, v27, s[48:51], s80 offen sc0 sc1
    v_lshlrev_b32 v22, 16, v19
    v_and_b32 v23, s88, v19
    s_waitcnt lgkmcnt(3)
    v_pk_add_f32 v[40:41], v[40:41], v[48:49]
    s_waitcnt lgkmcnt(2)
    v_pk_add_f32 v[42:43], v[42:43], v[50:51]
    s_waitcnt lgkmcnt(1)
    v_pk_add_f32 v[44:45], v[44:45], v[52:53]
    s_waitcnt lgkmcnt(0)
    v_pk_add_f32 v[46:47], v[46:47], v[54:55]
    v_pk_add_f32 v[40:41], v[40:41], v[44:45]
    v_pk_add_f32 v[42:43], v[42:43], v[46:47]
    v_pk_add_f32 v[40:41], v[40:41], v[42:43]
    s_nop 1
    v_fmac_f32_dpp v38, v24, v40 quad_perm:[3,3,3,3] row_mask:0xf bank_mask:0xf
    v_fmac_f32_dpp v39, v24, v41 quad_perm:[3,3,3,3] row_mask:0xf bank_mask:0xf
    v_pk_add_f32 v[22:23], v[22:23], v[38:39]
    v_cvt_pk_bf16_f32 v19, v22, v23
    buffer_store_dword v19, v27, s[48:51], s81 offen sc0 sc1
L_exit:
    s_endpgm
L_role_s:
    s_lshl_b32 s70, s62, 3
    s_add_u32 s70, s70, s61
    s_lshl_b32 s59, s61, 2
    s_add_u32 s59, s59, s62
    s_lshl_b32 s64, s59, 6
    s_add_u32 s64, s64, s60
    s_lshl_b32 s79, s64, 10
    s_lshl_b32 s74, s60, 13
    s_mov_b32 s68, 123904
    s_waitcnt lgkmcnt(0)
    s_mov_b32 s36, s4
    s_mov_b32 s37, s5
    buffer_load_dwordx4 v[32:35], v30, s[36:39], s79 offen
    s_add_u32 s79, s79, 8192
    buffer_load_dwordx4 v[36:39], v30, s[36:39], s79 offen
    s_add_u32 s79, s79, 8192
    buffer_load_dwordx4 v[40:43], v30, s[36:39], s79 offen
    s_add_u32 s79, s79, 8192
    buffer_load_dwordx4 v[44:47], v30, s[36:39], s79 offen
    s_add_u32 s79, s79, 8192
    buffer_load_dwordx4 v[48:51], v30, s[36:39], s79 offen
    s_add_u32 s79, s79, 8192
    buffer_load_dwordx4 v[52:55], v30, s[36:39], s79 offen
    s_add_u32 s79, s79, 8192
    buffer_load_dwordx4 v[56:59], v30, s[36:39], s79 offen
    s_add_u32 s79, s79, 8192
    buffer_load_dwordx4 v[60:63], v30, s[36:39], s79 offen
    s_add_u32 s79, s79, 8192
    s_lshl_b32 s58, s61, 5
    s_add_u32 s58, s58, s62
    s_lshl_b32 s66, s58, 2
    s_load_dword s63, s[34:35], 0
    s_load_dword s56, s[18:19], s66
    s_load_dword s57, s[20:21], s66
    s_lshl_b32 s65, s58, 1
    s_add_u32 s87, s86, s65
    s_bfe_u32 s77, s60, 0x10001
    s_lshr_b32 s93, s60, 2
    s_lshl_b32 s66, s87, 8
    s_lshl_b32 s65, s77, 7
    s_add_u32 s81, s66, s65
    v_lshl_add_u32 v218, v0, 1, s81
    s_and_b32 s64, s62, 3
    s_lshl_b32 s75, s61, 2
    s_add_u32 s75, s75, s64
    s_lshl_b32 s64, s64, 1
    s_lshr_b32 s65, s62, 2
    s_add_u32 s64, s64, s65
    s_and_b32 s76, s64, 7
    s_mov_b32 s88, 0xffff0000
    s_mov_b32 s46, 1835008
    s_mov_b32 s47, 0x20000
    s_mov_b32 s50, 2097152
    s_mov_b32 s51, 0x20000
    s_mov_b32 s54, 20971520
    s_mov_b32 s55, 0x20000
    s_mov_b32 s44, s28
    s_mov_b32 s45, s29
    s_mov_b32 s48, s30
    s_mov_b32 s49, s31
    s_mov_b32 s52, s34
    s_mov_b32 s53, s35
    global_load_ushort v212, v218, s[6:7]
    global_load_ushort v213, v218, s[8:9]
    s_cmp_ge_u32 s60, 4
    s_cbranch_scc1 L_par_40
    global_load_ushort v214, v218, s[10:11]
    global_load_ushort v215, v218, s[12:13]
    global_load_ushort v216, v218, s[14:15]
    global_load_ushort v217, v218, s[16:17]
L_par_40:
    v_bfe_u32 v24, v0, 3, 2
    v_mul_u32_u24 v24, 4160, v24
    v_lshrrev_b32 v25, 5, v0
    v_mul_u32_u24 v25, 16704, v25
    v_and_b32 v26, 7, v0
    v_lshl_add_u32 v24, v26, 2, v24
    v_add3_u32 v24, v24, v25, s68
    v_mov_b32 v25, 0
    ds_write_b32 v24, v25
    v_and_b32 v13, 31, v0
    v_lshlrev_b32 v13, 2, v13
    s_bfe_u32 s64, s60, 0x10001
    v_xor_b32 v12, s64, v0
    v_lshlrev_b32 v12, 7, v12
    s_and_b32 s64, s60, 1
    s_lshl_b32 s64, s64, 2
    v_and_b32 v11, 7, v0
    v_xor_b32 v11, s64, v11
    v_lshl_or_b32 v12, v11, 4, v12
    v_add_u32 v12, s74, v12
    v_bfe_u32 v14, v0, 2, 2
    v_lshlrev_b32 v11, 13, v14
    v_lshrrev_b32 v24, 1, v14
    v_lshl_or_b32 v11, v24, 7, v11
    v_and_b32 v14, 1, v14
    v_lshrrev_b32 v24, 4, v0
    v_lshlrev_b32 v24, 1, v24
    v_bfe_u32 v25, v0, 1, 1
    v_or_b32 v24, v24, v25
    v_lshlrev_b32 v14, 2, v14
    v_xor_b32 v24, v24, v14
    v_lshl_or_b32 v11, v24, 4, v11
    v_and_b32 v24, 1, v0
    v_lshl_or_b32 v11, v24, 3, v11
    s_lshl_b32 s64, s60, 10
    v_add_u32 v11, s64, v11
    v_lshrrev_b32 v14, 3, v0
    v_lshlrev_b32 v14, 5, v14
    s_waitcnt lgkmcnt(0)
    s_add_u32 s63, s63, 1
    s_xor_b32 s64, s86, 1
    s_lshl_b32 s64, s64, 4
    s_lshl_b32 s56, s56, s64
    s_and_b32 s56, s56, s88
    s_and_b32 s68, s57, s88
    s_lshl_b32 s57, s57, 16
    v_mov_b32 v23, s63
    s_waitcnt vmcnt(9)
    v_lshlrev_b32 v64, 16, v32
    v_and_b32 v65, s88, v32
    v_lshlrev_b32 v66, 16, v33
    v_and_b32 v67, s88, v33
    v_lshlrev_b32 v68, 16, v34
    v_and_b32 v69, s88, v34
    v_lshlrev_b32 v70, 16, v35
    v_and_b32 v71, s88, v35
    v_pk_add_f32 v[136:137], v[64:65], v[66:67]
    v_pk_add_f32 v[138:139], v[68:69], v[70:71]
    v_pk_add_f32 v[136:137], v[136:137], v[138:139]
    v_add_f32 v128, v136, v137
    s_waitcnt vmcnt(8)
    v_lshlrev_b32 v72, 16, v36
    v_and_b32 v73, s88, v36
    v_lshlrev_b32 v74, 16, v37
    v_and_b32 v75, s88, v37
    v_lshlrev_b32 v76, 16, v38
    v_and_b32 v77, s88, v38
    v_lshlrev_b32 v78, 16, v39
    v_and_b32 v79, s88, v39
    v_pk_add_f32 v[140:141], v[72:73], v[74:75]
    v_pk_add_f32 v[142:143], v[76:77], v[78:79]
    v_pk_add_f32 v[140:141], v[140:141], v[142:143]
    v_add_f32 v129, v140, v141
    s_waitcnt vmcnt(7)
    v_lshlrev_b32 v80, 16, v40
    v_and_b32 v81, s88, v40
    v_lshlrev_b32 v82, 16, v41
    v_and_b32 v83, s88, v41
    v_lshlrev_b32 v84, 16, v42
    v_and_b32 v85, s88, v42
    v_lshlrev_b32 v86, 16, v43
    v_and_b32 v87, s88, v43
    v_pk_add_f32 v[136:137], v[80:81], v[82:83]
    v_pk_add_f32 v[138:139], v[84:85], v[86:87]
    v_pk_add_f32 v[136:137], v[136:137], v[138:139]
    v_add_f32 v130, v136, v137
    s_waitcnt vmcnt(6)
    v_lshlrev_b32 v88, 16, v44
    v_and_b32 v89, s88, v44
    v_lshlrev_b32 v90, 16, v45
    v_and_b32 v91, s88, v45
    v_lshlrev_b32 v92, 16, v46
    v_and_b32 v93, s88, v46
    v_lshlrev_b32 v94, 16, v47
    v_and_b32 v95, s88, v47
    v_pk_add_f32 v[140:141], v[88:89], v[90:91]
    v_pk_add_f32 v[142:143], v[92:93], v[94:95]
    v_pk_add_f32 v[140:141], v[140:141], v[142:143]
    v_add_f32 v131, v140, v141
    s_waitcnt vmcnt(5)
    v_lshlrev_b32 v96, 16, v48
    v_and_b32 v97, s88, v48
    v_lshlrev_b32 v98, 16, v49
    v_and_b32 v99, s88, v49
    v_lshlrev_b32 v100, 16, v50
    v_and_b32 v101, s88, v50
    v_lshlrev_b32 v102, 16, v51
    v_and_b32 v103, s88, v51
    v_pk_add_f32 v[136:137], v[96:97], v[98:99]
    v_pk_add_f32 v[138:139], v[100:101], v[102:103]
    v_pk_add_f32 v[136:137], v[136:137], v[138:139]
    v_add_f32 v132, v136, v137
    s_waitcnt vmcnt(4)
    v_lshlrev_b32 v104, 16, v52
    v_and_b32 v105, s88, v52
    v_lshlrev_b32 v106, 16, v53
    v_and_b32 v107, s88, v53
    v_lshlrev_b32 v108, 16, v54
    v_and_b32 v109, s88, v54
    v_lshlrev_b32 v110, 16, v55
    v_and_b32 v111, s88, v55
    v_pk_add_f32 v[140:141], v[104:105], v[106:107]
    v_pk_add_f32 v[142:143], v[108:109], v[110:111]
    v_pk_add_f32 v[140:141], v[140:141], v[142:143]
    v_add_f32 v133, v140, v141
    s_waitcnt vmcnt(3)
    v_lshlrev_b32 v112, 16, v56
    v_and_b32 v113, s88, v56
    v_lshlrev_b32 v114, 16, v57
    v_and_b32 v115, s88, v57
    v_lshlrev_b32 v116, 16, v58
    v_and_b32 v117, s88, v58
    v_lshlrev_b32 v118, 16, v59
    v_and_b32 v119, s88, v59
    v_pk_add_f32 v[136:137], v[112:113], v[114:115]
    v_pk_add_f32 v[138:139], v[116:117], v[118:119]
    v_pk_add_f32 v[136:137], v[136:137], v[138:139]
    v_add_f32 v134, v136, v137
    s_waitcnt vmcnt(2)
    v_lshlrev_b32 v120, 16, v60
    v_and_b32 v121, s88, v60
    v_lshlrev_b32 v122, 16, v61
    v_and_b32 v123, s88, v61
    v_lshlrev_b32 v124, 16, v62
    v_and_b32 v125, s88, v62
    v_lshlrev_b32 v126, 16, v63
    v_and_b32 v127, s88, v63
    v_pk_add_f32 v[140:141], v[120:121], v[122:123]
    v_pk_add_f32 v[142:143], v[124:125], v[126:127]
    v_pk_add_f32 v[140:141], v[140:141], v[142:143]
    v_add_f32 v135, v140, v141
    v_permlane32_swap_b32 v128, v132
    v_permlane32_swap_b32 v129, v133
    v_permlane32_swap_b32 v130, v134
    v_permlane32_swap_b32 v131, v135
    v_add_f32 v128, v128, v132
    v_add_f32 v129, v129, v133
    v_add_f32 v130, v130, v134
    v_add_f32 v131, v131, v135
    s_nop 0
    v_permlane16_swap_b32 v128, v130
    v_permlane16_swap_b32 v129, v131
    v_add_f32 v128, v128, v130
    v_add_f32 v129, v129, v131
    s_nop 0
    v_add_f32_dpp v128, v128, v128 row_ror:8 row_mask:0xf bank_mask:0x3
    s_nop 1
    v_add_f32_dpp v128, v129, v129 row_ror:8 row_mask:0xf bank_mask:0xc
    s_nop 1
    v_add_f32_dpp v128, v128, v128 row_half_mirror row_mask:0xf bank_mask:0xf
    s_nop 1
    v_add_f32_dpp v128, v128, v128 quad_perm:[1,0,3,2] row_mask:0xf bank_mask:0xf
    s_nop 1
    v_add_f32_dpp v128, v128, v128 quad_perm:[2,3,0,1] row_mask:0xf bank_mask:0xf
    v_ldexp_f32 v128, v128, -9
    v_cvt_pk_bf16_f32 v24, v128, v128
    v_and_b32 v24, s88, v24
    v_sub_f32 v25, v128, v24
    v_readlane_b32 s4, v24, 0
    v_readlane_b32 s5, v24, 8
    v_readlane_b32 s6, v24, 16
    v_readlane_b32 s7, v24, 24
    v_readlane_b32 s8, v24, 32
    v_readlane_b32 s9, v24, 40
    v_readlane_b32 s10, v24, 48
    v_readlane_b32 s11, v24, 56
    v_pk_add_f32 v[64:65], v[64:65], s[4:5] op_sel:[0,0] op_sel_hi:[1,0] neg_lo:[0,1] neg_hi:[0,1]
    v_pk_add_f32 v[66:67], v[66:67], s[4:5] op_sel:[0,0] op_sel_hi:[1,0] neg_lo:[0,1] neg_hi:[0,1]
    v_pk_add_f32 v[68:69], v[68:69], s[4:5] op_sel:[0,0] op_sel_hi:[1,0] neg_lo:[0,1] neg_hi:[0,1]
    v_pk_add_f32 v[70:71], v[70:71], s[4:5] op_sel:[0,0] op_sel_hi:[1,0] neg_lo:[0,1] neg_hi:[0,1]
    v_pk_add_f32 v[72:73], v[72:73], s[4:5] op_sel:[0,1] op_sel_hi:[1,1] neg_lo:[0,1] neg_hi:[0,1]
    v_pk_add_f32 v[74:75], v[74:75], s[4:5] op_sel:[0,1] op_sel_hi:[1,1] neg_lo:[0,1] neg_hi:[0,1]
    v_pk_add_f32 v[76:77], v[76:77], s[4:5] op_sel:[0,1] op_sel_hi:[1,1] neg_lo:[0,1] neg_hi:[0,1]
    v_pk_add_f32 v[78:79], v[78:79], s[4:5] op_sel:[0,1] op_sel_hi:[1,1] neg_lo:[0,1] neg_hi:[0,1]
    v_pk_mul_f32 v[136:137], v[64:65], v[64:65]
    v_pk_mul_f32 v[138:139], v[72:73], v[72:73]
    v_pk_fma_f32 v[136:137], v[66:67], v[66:67], v[136:137]
    v_pk_fma_f32 v[138:139], v[74:75], v[74:75], v[138:139]
    v_pk_fma_f32 v[136:137], v[68:69], v[68:69], v[136:137]
    v_pk_fma_f32 v[138:139], v[76:77], v[76:77], v[138:139]
    v_pk_fma_f32 v[136:137], v[70:71], v[70:71], v[136:137]
    v_pk_fma_f32 v[138:139], v[78:79], v[78:79], v[138:139]
    v_add_f32 v128, v136, v137
    v_add_f32 v129, v138, v139
    v_pk_add_f32 v[80:81], v[80:81], s[6:7] op_sel:[0,0] op_sel_hi:[1,0] neg_lo:[0,1] neg_hi:[0,1]
    v_pk_add_f32 v[82:83], v[82:83], s[6:7] op_sel:[0,0] op_sel_hi:[1,0] neg_lo:[0,1] neg_hi:[0,1]
    v_pk_add_f32 v[84:85], v[84:85], s[6:7] op_sel:[0,0] op_sel_hi:[1,0] neg_lo:[0,1] neg_hi:[0,1]
    v_pk_add_f32 v[86:87], v[86:87], s[6:7] op_sel:[0,0] op_sel_hi:[1,0] neg_lo:[0,1] neg_hi:[0,1]
    v_pk_add_f32 v[88:89], v[88:89], s[6:7] op_sel:[0,1] op_sel_hi:[1,1] neg_lo:[0,1] neg_hi:[0,1]
    v_pk_add_f32 v[90:91], v[90:91], s[6:7] op_sel:[0,1] op_sel_hi:[1,1] neg_lo:[0,1] neg_hi:[0,1]
    v_pk_add_f32 v[92:93], v[92:93], s[6:7] op_sel:[0,1] op_sel_hi:[1,1] neg_lo:[0,1] neg_hi:[0,1]
    v_pk_add_f32 v[94:95], v[94:95], s[6:7] op_sel:[0,1] op_sel_hi:[1,1] neg_lo:[0,1] neg_hi:[0,1]
    v_pk_mul_f32 v[136:137], v[80:81], v[80:81]
    v_pk_mul_f32 v[138:139], v[88:89], v[88:89]
    v_pk_fma_f32 v[136:137], v[82:83], v[82:83], v[136:137]
    v_pk_fma_f32 v[138:139], v[90:91], v[90:91], v[138:139]
    v_pk_fma_f32 v[136:137], v[84:85], v[84:85], v[136:137]
    v_pk_fma_f32 v[138:139], v[92:93], v[92:93], v[138:139]
    v_pk_fma_f32 v[136:137], v[86:87], v[86:87], v[136:137]
    v_pk_fma_f32 v[138:139], v[94:95], v[94:95], v[138:139]
    v_add_f32 v130, v136, v137
    v_add_f32 v131, v138, v139
    v_pk_add_f32 v[96:97], v[96:97], s[8:9] op_sel:[0,0] op_sel_hi:[1,0] neg_lo:[0,1] neg_hi:[0,1]
    v_pk_add_f32 v[98:99], v[98:99], s[8:9] op_sel:[0,0] op_sel_hi:[1,0] neg_lo:[0,1] neg_hi:[0,1]
    v_pk_add_f32 v[100:101], v[100:101], s[8:9] op_sel:[0,0] op_sel_hi:[1,0] neg_lo:[0,1] neg_hi:[0,1]
    v_pk_add_f32 v[102:103], v[102:103], s[8:9] op_sel:[0,0] op_sel_hi:[1,0] neg_lo:[0,1] neg_hi:[0,1]
    v_pk_add_f32 v[104:105], v[104:105], s[8:9] op_sel:[0,1] op_sel_hi:[1,1] neg_lo:[0,1] neg_hi:[0,1]
    v_pk_add_f32 v[106:107], v[106:107], s[8:9] op_sel:[0,1] op_sel_hi:[1,1] neg_lo:[0,1] neg_hi:[0,1]
    v_pk_add_f32 v[108:109], v[108:109], s[8:9] op_sel:[0,1] op_sel_hi:[1,1] neg_lo:[0,1] neg_hi:[0,1]
    v_pk_add_f32 v[110:111], v[110:111], s[8:9] op_sel:[0,1] op_sel_hi:[1,1] neg_lo:[0,1] neg_hi:[0,1]
    v_pk_mul_f32 v[136:137], v[96:97], v[96:97]
    v_pk_mul_f32 v[138:139], v[104:105], v[104:105]
    v_pk_fma_f32 v[136:137], v[98:99], v[98:99], v[136:137]
    v_pk_fma_f32 v[138:139], v[106:107], v[106:107], v[138:139]
    v_pk_fma_f32 v[136:137], v[100:101], v[100:101], v[136:137]
    v_pk_fma_f32 v[138:139], v[108:109], v[108:109], v[138:139]
    v_pk_fma_f32 v[136:137], v[102:103], v[102:103], v[136:137]
    v_pk_fma_f32 v[138:139], v[110:111], v[110:111], v[138:139]
    v_add_f32 v132, v136, v137
    v_add_f32 v133, v138, v139
    v_pk_add_f32 v[112:113], v[112:113], s[10:11] op_sel:[0,0] op_sel_hi:[1,0] neg_lo:[0,1] neg_hi:[0,1]
    v_pk_add_f32 v[114:115], v[114:115], s[10:11] op_sel:[0,0] op_sel_hi:[1,0] neg_lo:[0,1] neg_hi:[0,1]
    v_pk_add_f32 v[116:117], v[116:117], s[10:11] op_sel:[0,0] op_sel_hi:[1,0] neg_lo:[0,1] neg_hi:[0,1]
    v_pk_add_f32 v[118:119], v[118:119], s[10:11] op_sel:[0,0] op_sel_hi:[1,0] neg_lo:[0,1] neg_hi:[0,1]
    v_pk_add_f32 v[120:121], v[120:121], s[10:11] op_sel:[0,1] op_sel_hi:[1,1] neg_lo:[0,1] neg_hi:[0,1]
    v_pk_add_f32 v[122:123], v[122:123], s[10:11] op_sel:[0,1] op_sel_hi:[1,1] neg_lo:[0,1] neg_hi:[0,1]
    v_pk_add_f32 v[124:125], v[124:125], s[10:11] op_sel:[0,1] op_sel_hi:[1,1] neg_lo:[0,1] neg_hi:[0,1]
    v_pk_add_f32 v[126:127], v[126:127], s[10:11] op_sel:[0,1] op_sel_hi:[1,1] neg_lo:[0,1] neg_hi:[0,1]
    v_pk_mul_f32 v[136:137], v[112:113], v[112:113]
    v_pk_mul_f32 v[138:139], v[120:121], v[120:121]
    v_pk_fma_f32 v[136:137], v[114:115], v[114:115], v[136:137]
    v_pk_fma_f32 v[138:139], v[122:123], v[122:123], v[138:139]
    v_pk_fma_f32 v[136:137], v[116:117], v[116:117], v[136:137]
    v_pk_fma_f32 v[138:139], v[124:125], v[124:125], v[138:139]
    v_pk_fma_f32 v[136:137], v[118:119], v[118:119], v[136:137]
    v_pk_fma_f32 v[138:139], v[126:127], v[126:127], v[138:139]
    v_add_f32 v134, v136, v137
    v_add_f32 v135, v138, v139
    v_permlane32_swap_b32 v128, v132
    v_cvt_pk_bf16_f32 v32, v64, v65
    v_cvt_pk_bf16_f32 v33, v66, v67
    v_permlane32_swap_b32 v129, v133
    v_cvt_pk_bf16_f32 v34, v68, v69
    v_cvt_pk_bf16_f32 v35, v70, v71
    v_permlane32_swap_b32 v130, v134
    v_lshlrev_b32 v64, 16, v32
    v_and_b32 v65, s88, v32
    v_permlane32_swap_b32 v131, v135
    v_lshlrev_b32 v66, 16, v33
    v_and_b32 v67, s88, v33
    v_add_f32 v128, v128, v132
    v_lshlrev_b32 v68, 16, v34
    v_and_b32 v69, s88, v34
    v_add_f32 v129, v129, v133
    v_lshlrev_b32 v70, 16, v35
    v_and_b32 v71, s88, v35
    v_add_f32 v130, v130, v134
    v_cvt_pk_bf16_f32 v36, v72, v73
    v_cvt_pk_bf16_f32 v37, v74, v75
    v_add_f32 v131, v131, v135
    v_cvt_pk_bf16_f32 v38, v76, v77
    v_cvt_pk_bf16_f32 v39, v78, v79
    v_permlane16_swap_b32 v128, v130
    v_lshlrev_b32 v72, 16, v36
    v_and_b32 v73, s88, v36
    v_permlane16_swap_b32 v129, v131
    v_lshlrev_b32 v74, 16, v37
    v_and_b32 v75, s88, v37
    v_add_f32 v128, v128, v130
    v_lshlrev_b32 v76, 16, v38
    v_and_b32 v77, s88, v38
    v_add_f32 v129, v129, v131
    v_lshlrev_b32 v78, 16, v39
    v_and_b32 v79, s88, v39
    v_add_f32_dpp v128, v128, v128 row_ror:8 row_mask:0xf bank_mask:0x3
    v_cvt_pk_bf16_f32 v40, v80, v81
    v_cvt_pk_bf16_f32 v41, v82, v83
    v_add_f32_dpp v128, v129, v129 row_ror:8 row_mask:0xf bank_mask:0xc
    v_cvt_pk_bf16_f32 v42, v84, v85
    v_cvt_pk_bf16_f32 v43, v86, v87
    v_add_f32_dpp v128, v128, v128 row_half_mirror row_mask:0xf bank_mask:0xf
    v_lshlrev_b32 v80, 16, v40
    v_and_b32 v81, s88, v40
    v_add_f32_dpp v128, v128, v128 quad_perm:[1,0,3,2] row_mask:0xf bank_mask:0xf
    v_lshlrev_b32 v82, 16, v41
    v_and_b32 v83, s88, v41
    v_add_f32_dpp v128, v128, v128 quad_perm:[2,3,0,1] row_mask:0xf bank_mask:0xf
    v_lshlrev_b32 v84, 16, v42
    v_and_b32 v85, s88, v42
    v_ldexp_f32 v128, v128, -9
    v_lshlrev_b32 v86, 16, v43
    v_and_b32 v87, s88, v43
    v_fma_f32 v128, -v25, v25, v128
    v_cvt_pk_bf16_f32 v44, v88, v89
    v_cvt_pk_bf16_f32 v45, v90, v91
    v_max_f32 v128, 0, v128
    v_cvt_pk_bf16_f32 v46, v92, v93
    v_cvt_pk_bf16_f32 v47, v94, v95
    v_cvt_pk_bf16_f32 v128, v128, v128
    v_lshlrev_b32 v88, 16, v44
    v_and_b32 v89, s88, v44
    v_and_b32 v128, s88, v128
    v_lshlrev_b32 v90, 16, v45
    v_and_b32 v91, s88, v45
    v_add_f32 v128, 0x3727c5ac, v128
    v_lshlrev_b32 v92, 16, v46
    v_and_b32 v93, s88, v46
    v_cvt_pk_bf16_f32 v128, v128, v128
    v_lshlrev_b32 v94, 16, v47
    v_and_b32 v95, s88, v47
    v_and_b32 v128, s88, v128
    v_cvt_pk_bf16_f32 v48, v96, v97
    v_cvt_pk_bf16_f32 v49, v98, v99
    v_sqrt_f32 v128, v128
    v_cvt_pk_bf16_f32 v50, v100, v101
    v_cvt_pk_bf16_f32 v51, v102, v103
    v_cvt_pk_bf16_f32 v128, v128, v128
    v_lshlrev_b32 v96, 16, v48
    v_and_b32 v97, s88, v48
    v_and_b32 v128, s88, v128
    v_lshlrev_b32 v98, 16, v49
    v_and_b32 v99, s88, v49
    v_rcp_f32 v129, v128
    v_lshlrev_b32 v100, 16, v50
    v_and_b32 v101, s88, v50
    v_fma_f32 v130, -v128, v129, 1.0
    v_lshlrev_b32 v102, 16, v51
    v_and_b32 v103, s88, v51
    v_fma_f32 v129, v130, v129, v129
    v_cvt_pk_bf16_f32 v52, v104, v105
    v_cvt_pk_bf16_f32 v53, v106, v107
    v_mul_f32 v25, v129, v129
    v_cvt_pk_bf16_f32 v54, v108, v109
    v_cvt_pk_bf16_f32 v55, v110, v111
    v_readlane_b32 s12, v129, 0
    v_lshlrev_b32 v104, 16, v52
    v_and_b32 v105, s88, v52
    v_readlane_b32 s13, v129, 8
    v_lshlrev_b32 v106, 16, v53
    v_and_b32 v107, s88, v53
    v_readlane_b32 s14, v129, 16
    v_lshlrev_b32 v108, 16, v54
    v_and_b32 v109, s88, v54
    v_readlane_b32 s15, v129, 24
    v_lshlrev_b32 v110, 16, v55
    v_and_b32 v111, s88, v55
    v_readlane_b32 s16, v129, 32
    v_cvt_pk_bf16_f32 v56, v112, v113
    v_cvt_pk_bf16_f32 v57, v114, v115
    v_readlane_b32 s17, v129, 40
    v_cvt_pk_bf16_f32 v58, v116, v117
    v_cvt_pk_bf16_f32 v59, v118, v119
    v_readlane_b32 s18, v129, 48
    v_lshlrev_b32 v112, 16, v56
    v_and_b32 v113, s88, v56
    v_readlane_b32 s19, v129, 56
    v_lshlrev_b32 v114, 16, v57
    v_and_b32 v115, s88, v57
    v_lshlrev_b32 v116, 16, v58
    v_and_b32 v117, s88, v58
    v_lshlrev_b32 v118, 16, v59
    v_and_b32 v119, s88, v59
    v_cvt_pk_bf16_f32 v60, v120, v121
    v_cvt_pk_bf16_f32 v61, v122, v123
    v_cvt_pk_bf16_f32 v62, v124, v125
    v_cvt_pk_bf16_f32 v63, v126, v127
    v_lshlrev_b32 v120, 16, v60
    v_and_b32 v121, s88, v60
    v_lshlrev_b32 v122, 16, v61
    v_and_b32 v123, s88, v61
    v_lshlrev_b32 v124, 16, v62
    v_and_b32 v125, s88, v62
    v_lshlrev_b32 v126, 16, v63
    v_and_b32 v127, s88, v63
    v_pk_mul_f32 v[64:65], v[64:65], s[12:13] op_sel:[0,0] op_sel_hi:[1,0]
    v_pk_mul_f32 v[66:67], v[66:67], s[12:13] op_sel:[0,0] op_sel_hi:[1,0]
    v_pk_mul_f32 v[68:69], v[68:69], s[12:13] op_sel:[0,0] op_sel_hi:[1,0]
    v_pk_mul_f32 v[70:71], v[70:71], s[12:13] op_sel:[0,0] op_sel_hi:[1,0]
    v_pk_mul_f32 v[72:73], v[72:73], s[12:13] op_sel:[0,1] op_sel_hi:[1,1]
    v_pk_mul_f32 v[74:75], v[74:75], s[12:13] op_sel:[0,1] op_sel_hi:[1,1]
    v_pk_mul_f32 v[76:77], v[76:77], s[12:13] op_sel:[0,1] op_sel_hi:[1,1]
    v_pk_mul_f32 v[78:79], v[78:79], s[12:13] op_sel:[0,1] op_sel_hi:[1,1]
    v_pk_mul_f32 v[80:81], v[80:81], s[14:15] op_sel:[0,0] op_sel_hi:[1,0]
    v_pk_mul_f32 v[82:83], v[82:83], s[14:15] op_sel:[0,0] op_sel_hi:[1,0]
    v_pk_mul_f32 v[84:85], v[84:85], s[14:15] op_sel:[0,0] op_sel_hi:[1,0]
    v_pk_mul_f32 v[86:87], v[86:87], s[14:15] op_sel:[0,0] op_sel_hi:[1,0]
    v_pk_mul_f32 v[88:89], v[88:89], s[14:15] op_sel:[0,1] op_sel_hi:[1,1]
    v_pk_mul_f32 v[90:91], v[90:91], s[14:15] op_sel:[0,1] op_sel_hi:[1,1]
    v_pk_mul_f32 v[92:93], v[92:93], s[14:15] op_sel:[0,1] op_sel_hi:[1,1]
    v_pk_mul_f32 v[94:95], v[94:95], s[14:15] op_sel:[0,1] op_sel_hi:[1,1]
    v_pk_mul_f32 v[96:97], v[96:97], s[16:17] op_sel:[0,0] op_sel_hi:[1,0]
    v_pk_mul_f32 v[98:99], v[98:99], s[16:17] op_sel:[0,0] op_sel_hi:[1,0]
    v_pk_mul_f32 v[100:101], v[100:101], s[16:17] op_sel:[0,0] op_sel_hi:[1,0]
    v_pk_mul_f32 v[102:103], v[102:103], s[16:17] op_sel:[0,0] op_sel_hi:[1,0]
    v_pk_mul_f32 v[104:105], v[104:105], s[16:17] op_sel:[0,1] op_sel_hi:[1,1]
    v_pk_mul_f32 v[106:107], v[106:107], s[16:17] op_sel:[0,1] op_sel_hi:[1,1]
    v_pk_mul_f32 v[108:109], v[108:109], s[16:17] op_sel:[0,1] op_sel_hi:[1,1]
    v_pk_mul_f32 v[110:111], v[110:111], s[16:17] op_sel:[0,1] op_sel_hi:[1,1]
    v_pk_mul_f32 v[112:113], v[112:113], s[18:19] op_sel:[0,0] op_sel_hi:[1,0]
    v_pk_mul_f32 v[114:115], v[114:115], s[18:19] op_sel:[0,0] op_sel_hi:[1,0]
    v_pk_mul_f32 v[116:117], v[116:117], s[18:19] op_sel:[0,0] op_sel_hi:[1,0]
    v_pk_mul_f32 v[118:119], v[118:119], s[18:19] op_sel:[0,0] op_sel_hi:[1,0]
    v_pk_mul_f32 v[120:121], v[120:121], s[18:19] op_sel:[0,1] op_sel_hi:[1,1]
    v_pk_mul_f32 v[122:123], v[122:123], s[18:19] op_sel:[0,1] op_sel_hi:[1,1]
    v_pk_mul_f32 v[124:125], v[124:125], s[18:19] op_sel:[0,1] op_sel_hi:[1,1]
    v_pk_mul_f32 v[126:127], v[126:127], s[18:19] op_sel:[0,1] op_sel_hi:[1,1]
    v_cvt_pk_bf16_f32 v32, v64, v65
    v_cvt_pk_bf16_f32 v33, v72, v73
    v_cvt_pk_bf16_f32 v34, v80, v81
    v_cvt_pk_bf16_f32 v35, v88, v89
    v_xor_b32 v136, 0, v12
    ds_write_b128 v136, v[32:35]
    v_cvt_pk_bf16_f32 v36, v96, v97
    v_cvt_pk_bf16_f32 v37, v104, v105
    v_cvt_pk_bf16_f32 v38, v112, v113
    v_cvt_pk_bf16_f32 v39, v120, v121
    v_xor_b32 v137, 16, v12
    ds_write_b128 v137, v[36:39]
    v_cvt_pk_bf16_f32 v40, v66, v67
    v_cvt_pk_bf16_f32 v41, v74, v75
    v_cvt_pk_bf16_f32 v42, v82, v83
    v_cvt_pk_bf16_f32 v43, v90, v91
    v_xor_b32 v138, 32, v12
    ds_write_b128 v138, v[40:43]
    v_cvt_pk_bf16_f32 v44, v98, v99
    v_cvt_pk_bf16_f32 v45, v106, v107
    v_cvt_pk_bf16_f32 v46, v114, v115
    v_cvt_pk_bf16_f32 v47, v122, v123
    v_xor_b32 v139, 48, v12
    ds_write_b128 v139, v[44:47]
    v_cvt_pk_bf16_f32 v48, v68, v69
    v_cvt_pk_bf16_f32 v49, v76, v77
    v_cvt_pk_bf16_f32 v50, v84, v85
    v_cvt_pk_bf16_f32 v51, v92, v93
    v_xor_b32 v136, 64, v12
    ds_write_b128 v136, v[48:51]
    v_cvt_pk_bf16_f32 v52, v100, v101
    v_cvt_pk_bf16_f32 v53, v108, v109
    v_cvt_pk_bf16_f32 v54, v116, v117
    v_cvt_pk_bf16_f32 v55, v124, v125
    v_xor_b32 v137, 80, v12
    ds_write_b128 v137, v[52:55]
    v_cvt_pk_bf16_f32 v56, v70, v71
    v_cvt_pk_bf16_f32 v57, v78, v79
    v_cvt_pk_bf16_f32 v58, v86, v87
    v_cvt_pk_bf16_f32 v59, v94, v95
    v_xor_b32 v138, 96, v12
    ds_write_b128 v138, v[56:59]
    v_cvt_pk_bf16_f32 v60, v102, v103
    v_cvt_pk_bf16_f32 v61, v110, v111
    v_cvt_pk_bf16_f32 v62, v118, v119
    v_cvt_pk_bf16_f32 v63, v126, v127
    v_xor_b32 v139, 112, v12
    ds_write_b128 v139, v[60:63]
    s_lshl_b32 s64, s59, 6
    s_add_u32 s64, s64, s60
    s_lshl_b32 s64, s64, 2
    s_add_u32 s65, s64, 73728
    s_add_u32 s64, s64, 65536
    s_mov_b32 exec_lo, 0x1010101
    s_mov_b32 exec_hi, 0x1010101
    buffer_store_dword v24, v14, s[52:55], s64 offen sc1
    buffer_store_dword v25, v14, s[52:55], s65 offen sc1
    s_mov_b64 exec, -1
    s_lshl_b32 s64, s59, 3
    s_add_u32 s64, s64, s60
    s_lshl_b32 s65, s64, 13
    s_add_u32 s79, s65, 1048576
    s_lshl_b32 s64, s70, 3
    s_add_u32 s64, s64, s60
    s_lshl_b32 s64, s64, 11
    s_add_u32 s90, s64, 14680064
    s_lshl_b32 s65, s59, 7
    s_add_u32 s82, s65, 102400
    v_lshrrev_b32 v9, 1, v30
    s_lshl_b32 s64, s60, 9
    s_add_u32 s95, s64, 65536
    v_add_u32 v10, s95, v9
    s_waitcnt lgkmcnt(0)
    s_barrier
    v_xor_b32 v128, 0, v11
    ds_read_b64_tr_b16 v[32:33], v128
    ds_read_b64_tr_b16 v[34:35], v128 offset:32768
    v_xor_b32 v129, 144, v11
    ds_read_b64_tr_b16 v[36:37], v129
    ds_read_b64_tr_b16 v[38:39], v129 offset:32768
    v_xor_b32 v130, 288, v11
    ds_read_b64_tr_b16 v[40:41], v130
    ds_read_b64_tr_b16 v[42:43], v130 offset:32768
    v_xor_b32 v131, 432, v11
    ds_read_b64_tr_b16 v[44:45], v131
    ds_read_b64_tr_b16 v[46:47], v131 offset:32768
    v_xor_b32 v132, 576, v11
    ds_read_b64_tr_b16 v[48:49], v132
    ds_read_b64_tr_b16 v[50:51], v132 offset:32768
    v_xor_b32 v133, 720, v11
    ds_read_b64_tr_b16 v[52:53], v133
    ds_read_b64_tr_b16 v[54:55], v133 offset:32768
    v_xor_b32 v134, 864, v11
    ds_read_b64_tr_b16 v[56:57], v134
    ds_read_b64_tr_b16 v[58:59], v134 offset:32768
    v_xor_b32 v135, 1008, v11
    ds_read_b64_tr_b16 v[60:61], v135
    ds_read_b64_tr_b16 v[62:63], v135 offset:32768
    s_waitcnt lgkmcnt(14)
    buffer_store_dwordx4 v[32:35], v30, s[52:55], s79 offen offset:0 sc1
    s_waitcnt lgkmcnt(12)
    buffer_store_dwordx4 v[36:39], v30, s[52:55], s79 offen offset:1024 sc1
    s_waitcnt lgkmcnt(10)
    buffer_store_dwordx4 v[40:43], v30, s[52:55], s79 offen offset:2048 sc1
    s_waitcnt lgkmcnt(8)
    buffer_store_dwordx4 v[44:47], v30, s[52:55], s79 offen offset:3072 sc1
    s_add_u32 s79, s79, 4096
    s_waitcnt lgkmcnt(6)
    buffer_store_dwordx4 v[48:51], v30, s[52:55], s79 offen offset:0 sc1
    s_waitcnt lgkmcnt(4)
    buffer_store_dwordx4 v[52:55], v30, s[52:55], s79 offen offset:1024 sc1
    s_waitcnt lgkmcnt(2)
    buffer_store_dwordx4 v[56:59], v30, s[52:55], s79 offen offset:2048 sc1
    s_waitcnt lgkmcnt(0)
    buffer_store_dwordx4 v[60:63], v30, s[52:55], s79 offen offset:3072 sc1
    buffer_load_dwordx4 v[64:67], v30, s[52:55], s90 offen offset:0 sc1
    buffer_load_dwordx4 v[68:71], v30, s[52:55], s90 offen offset:1024 sc1
    s_cmp_ge_u32 s60, 4
    s_cbranch_scc1 L_tv_41
    v_mov_b32 v210, s56
    s_mov_b32 s3, 0x3fb8aa3b
    v_mul_f32 v218, s3, v210
    v_fma_f32 v219, v210, s3, -v218
    v_fmamk_f32 v219, v210, 0x32a57060, v219
    v_exp_f32 v218, v218
    v_mul_f32 v219, 0x3f317218, v219
    v_fma_f32 v218, v218, v219, v218
    v_cvt_pk_bf16_f32 v218, v218, v218
    v_and_b32 v218, s88, v218
    s_waitcnt vmcnt(13)
    v_lshlrev_b32 v212, 16, v212
    s_waitcnt vmcnt(12)
    v_lshlrev_b32 v213, 16, v213
    v_lshlrev_b32 v214, 16, v214
    v_lshlrev_b32 v215, 16, v215
    v_lshlrev_b32 v216, 16, v216
    v_lshlrev_b32 v217, 16, v217
    v_mul_f32 v212, v218, v212
    v_mul_f32 v213, v218, v213
    v_mul_f32 v212, s3, v212
    v_mul_f32 v213, 0xbe22f983, v213
    v_mul_f32 v214, v218, v214
    v_mul_f32 v215, v218, v215
    v_mul_f32 v210, 1.0, v212
    v_mul_f32 v211, 1.0, v213
    v_exp_f32 v210, v210
    v_fract_f32 v211, v211
    v_cos_f32 v192, v211
    v_sin_f32 v193, v211
    v_mul_f32 v192, v210, v192
    v_mul_f32 v193, v210, v193
    v_mul_f32 v202, v214, v216
    v_mul_f32 v203, v214, v217
    v_fma_f32 v202, -v215, v217, v202
    v_fmac_f32 v203, v215, v216
    v_mul_f32 v210, 0x43800000, v212
    v_mul_f32 v211, 0x43800000, v213
    v_exp_f32 v210, v210
    v_fract_f32 v211, v211
    v_cos_f32 v200, v211
    v_sin_f32 v201, v211
    v_mul_f32 v200, v210, v200
    v_mul_f32 v201, v210, v201
    v_sub_f32 v203, 0, v203
    v_mul_f32 v194, v192, v192
    v_mul_f32 v195, v192, v193
    v_fma_f32 v194, -v193, v193, v194
    v_fmac_f32 v195, v193, v192
    v_cvt_pk_bf16_f32 v224, v202, v203
    v_mul_f32 v196, v194, v194
    v_mul_f32 v197, v194, v195
    v_fma_f32 v196, -v195, v195, v196
    v_fmac_f32 v197, v195, v194
    v_mul_f32 v198, v196, v196
    v_mul_f32 v199, v196, v197
    v_fma_f32 v198, -v197, v197, v198
    v_fmac_f32 v199, v197, v196
    v_mul_f32 v206, v202, v192
    v_mul_f32 v207, v202, v193
    v_fma_f32 v206, -v203, v193, v206
    v_fmac_f32 v207, v203, v192
    v_cvt_pk_bf16_f32 v225, v206, v207
    v_mul_f32 v208, v206, v192
    v_mul_f32 v209, v206, v193
    v_fma_f32 v208, -v207, v193, v208
    v_fmac_f32 v209, v207, v192
    v_cvt_pk_bf16_f32 v226, v208, v209
    v_mul_f32 v206, v208, v192
    v_mul_f32 v207, v208, v193
    v_fma_f32 v206, -v209, v193, v206
    v_fmac_f32 v207, v209, v192
    v_cvt_pk_bf16_f32 v227, v206, v207
    v_mul_f32 v208, v206, v192
    v_mul_f32 v209, v206, v193
    v_fma_f32 v208, -v207, v193, v208
    v_fmac_f32 v209, v207, v192
    v_cvt_pk_bf16_f32 v228, v208, v209
    v_mul_f32 v206, v208, v192
    v_mul_f32 v207, v208, v193
    v_fma_f32 v206, -v209, v193, v206
    v_fmac_f32 v207, v209, v192
    v_cvt_pk_bf16_f32 v229, v206, v207
    v_mul_f32 v208, v206, v192
    v_mul_f32 v209, v206, v193
    v_fma_f32 v208, -v207, v193, v208
    v_fmac_f32 v209, v207, v192
    v_cvt_pk_bf16_f32 v230, v208, v209
    v_mul_f32 v206, v208, v192
    v_mul_f32 v207, v208, v193
    v_fma_f32 v206, -v209, v193, v206
    v_fmac_f32 v207, v209, v192
    v_cvt_pk_bf16_f32 v231, v206, v207
    v_mul_f32 v204, v202, v200
    v_mul_f32 v205, v202, v201
    v_fma_f32 v204, -v203, v201, v204
    v_fmac_f32 v205, v203, v200
    v_cvt_pk_bf16_f32 v232, v204, v205
    v_mul_f32 v206, v204, v194
    v_mul_f32 v207, v204, v195
    v_fma_f32 v206, -v205, v195, v206
    v_fmac_f32 v207, v205, v194
    s_branch L_td_42
L_tv_41:
    v_mov_b32 v210, s56
    s_mov_b32 s3, 0x3fb8aa3b
    v_mul_f32 v218, s3, v210
    v_fma_f32 v219, v210, s3, -v218
    v_fmamk_f32 v219, v210, 0x32a57060, v219
    v_exp_f32 v218, v218
    v_mul_f32 v219, 0x3f317218, v219
    v_fma_f32 v218, v218, v219, v218
    v_cvt_pk_bf16_f32 v218, v218, v218
    v_and_b32 v218, s88, v218
    s_waitcnt vmcnt(13)
    v_lshlrev_b32 v212, 16, v212
    s_waitcnt vmcnt(12)
    v_lshlrev_b32 v213, 16, v213
    v_mul_f32 v212, v218, v212
    v_mul_f32 v213, v218, v213
    v_mul_f32 v212, s3, v212
    v_mul_f32 v213, 0x3e22f983, v213
    v_mul_f32 v210, 0x41000000, v212
    v_mul_f32 v211, 0x41000000, v213
    v_exp_f32 v210, v210
    v_fract_f32 v211, v211
    v_cos_f32 v198, v211
    v_sin_f32 v199, v211
    v_mul_f32 v198, v210, v198
    v_mul_f32 v199, v210, v199
    v_mul_f32 v210, 0x43000000, v212
    v_mul_f32 v211, 0x43000000, v213
    v_exp_f32 v210, v210
    v_fract_f32 v211, v211
    v_cos_f32 v194, v211
    v_sin_f32 v195, v211
    v_mul_f32 v194, v210, v194
    v_mul_f32 v195, v210, v195
    v_mov_b32 v206, 1.0
    v_mov_b32 v207, 0
    v_cvt_pk_bf16_f32 v224, v206, v207
    v_cvt_pk_bf16_f32 v225, v194, v195
    v_mul_f32 v208, v206, v198
    v_mul_f32 v209, v206, v199
    v_fma_f32 v208, -v207, v199, v208
    v_fmac_f32 v209, v207, v198
    v_mul_f32 v196, v194, v198
    v_mul_f32 v197, v194, v199
    v_fma_f32 v196, -v195, v199, v196
    v_fmac_f32 v197, v195, v198
    v_cvt_pk_bf16_f32 v226, v208, v209
    v_cvt_pk_bf16_f32 v227, v196, v197
    v_mul_f32 v206, v208, v198
    v_mul_f32 v207, v208, v199
    v_fma_f32 v206, -v209, v199, v206
    v_fmac_f32 v207, v209, v198
    v_mul_f32 v194, v196, v198
    v_mul_f32 v195, v196, v199
    v_fma_f32 v194, -v197, v199, v194
    v_fmac_f32 v195, v197, v198
    v_cvt_pk_bf16_f32 v228, v206, v207
    v_cvt_pk_bf16_f32 v229, v194, v195
    v_mul_f32 v208, v206, v198
    v_mul_f32 v209, v206, v199
    v_fma_f32 v208, -v207, v199, v208
    v_fmac_f32 v209, v207, v198
    v_mul_f32 v196, v194, v198
    v_mul_f32 v197, v194, v199
    v_fma_f32 v196, -v195, v199, v196
    v_fmac_f32 v197, v195, v198
    v_cvt_pk_bf16_f32 v230, v208, v209
    v_cvt_pk_bf16_f32 v231, v196, v197
    v_mul_f32 v206, v208, v198
    v_mul_f32 v207, v208, v199
    v_fma_f32 v206, -v209, v199, v206
    v_fmac_f32 v207, v209, v198
    v_mul_f32 v194, v196, v198
    v_mul_f32 v195, v196, v199
    v_fma_f32 v194, -v197, v199, v194
    v_fmac_f32 v195, v197, v198
    v_cvt_pk_bf16_f32 v232, v206, v207
    v_cvt_pk_bf16_f32 v233, v194, v195
    v_mul_f32 v208, v206, v198
    v_mul_f32 v209, v206, v199
    v_fma_f32 v208, -v207, v199, v208
    v_fmac_f32 v209, v207, v198
    v_mul_f32 v196, v194, v198
    v_mul_f32 v197, v194, v199
    v_fma_f32 v196, -v195, v199, v196
    v_fmac_f32 v197, v195, v198
    v_cvt_pk_bf16_f32 v234, v208, v209
    v_cvt_pk_bf16_f32 v235, v196, v197
    v_mul_f32 v206, v208, v198
    v_mul_f32 v207, v208, v199
    v_fma_f32 v206, -v209, v199, v206
    v_fmac_f32 v207, v209, v198
    v_mul_f32 v194, v196, v198
    v_mul_f32 v195, v196, v199
    v_fma_f32 v194, -v197, v199, v194
    v_fmac_f32 v195, v197, v198
    v_cvt_pk_bf16_f32 v236, v206, v207
    v_cvt_pk_bf16_f32 v237, v194, v195
    v_mul_f32 v208, v206, v198
    v_mul_f32 v209, v206, v199
    v_fma_f32 v208, -v207, v199, v208
    v_fmac_f32 v209, v207, v198
L_td_42:
    s_waitcnt vmcnt(2)
    s_barrier
    s_cmp_lg_u32 s60, 0
    s_cbranch_scc1 L_w0_43
    buffer_store_dword v23, v13, s[52:55], s82 offen sc1
L_w0_43:
    s_cmp_ge_u32 s60, 4
    s_cbranch_scc1 L_tv_44
    v_cvt_pk_bf16_f32 v233, v206, v207
    v_mul_f32 v208, v204, v196
    v_mul_f32 v209, v204, v197
    v_fma_f32 v208, -v205, v197, v208
    v_fmac_f32 v209, v205, v196
    v_cvt_pk_bf16_f32 v234, v208, v209
    v_mul_f32 v206, v208, v194
    v_mul_f32 v207, v208, v195
    v_fma_f32 v206, -v209, v195, v206
    v_fmac_f32 v207, v209, v194
    v_cvt_pk_bf16_f32 v235, v206, v207
    v_mul_f32 v208, v204, v198
    v_mul_f32 v209, v204, v199
    v_fma_f32 v208, -v205, v199, v208
    v_fmac_f32 v209, v205, v198
    v_cvt_pk_bf16_f32 v236, v208, v209
    v_mul_f32 v202, v204, v200
    v_mul_f32 v203, v204, v201
    v_fma_f32 v202, -v205, v201, v202
    v_fmac_f32 v203, v205, v200
    v_cvt_pk_bf16_f32 v237, v202, v203
    v_mul_f32 v206, v202, v196
    v_mul_f32 v207, v202, v197
    v_fma_f32 v206, -v203, v197, v206
    v_fmac_f32 v207, v203, v196
    v_cvt_pk_bf16_f32 v238, v206, v207
    v_mul_f32 v208, v202, v198
    v_mul_f32 v209, v202, v199
    v_fma_f32 v208, -v203, v199, v208
    v_fmac_f32 v209, v203, v198
    v_cvt_pk_bf16_f32 v239, v208, v209
    v_mul_f32 v204, v202, v200
    v_mul_f32 v205, v202, v201
    v_fma_f32 v204, -v203, v201, v204
    v_fmac_f32 v205, v203, v200
    v_cvt_pk_bf16_f32 v240, v204, v205
    v_mul_f32 v206, v204, v196
    v_mul_f32 v207, v204, v197
    v_fma_f32 v206, -v205, v197, v206
    v_fmac_f32 v207, v205, v196
    v_cvt_pk_bf16_f32 v241, v206, v207
    v_mul_f32 v208, v204, v198
    v_mul_f32 v209, v204, v199
    v_fma_f32 v208, -v205, v199, v208
    v_fmac_f32 v209, v205, v198
    v_cvt_pk_bf16_f32 v242, v208, v209
    v_mul_f32 v202, v204, v200
    v_mul_f32 v203, v204, v201
    v_fma_f32 v202, -v205, v201, v202
    v_fmac_f32 v203, v205, v200
    v_cvt_pk_bf16_f32 v243, v202, v203
    v_mul_f32 v206, v202, v198
    v_mul_f32 v207, v202, v199
    v_fma_f32 v206, -v203, v199, v206
    v_fmac_f32 v207, v203, v198
    v_cvt_pk_bf16_f32 v244, v206, v207
    v_mul_f32 v204, v202, v200
    v_mul_f32 v205, v202, v201
    v_fma_f32 v204, -v203, v201, v204
    v_fmac_f32 v205, v203, v200
    v_cvt_pk_bf16_f32 v245, v204, v205
    v_mul_f32 v206, v204, v198
    v_mul_f32 v207, v204, v199
    v_fma_f32 v206, -v205, v199, v206
    v_fmac_f32 v207, v205, v198
    v_cvt_pk_bf16_f32 v246, v206, v207
    v_mul_f32 v202, v204, v200
    v_mul_f32 v203, v204, v201
    v_fma_f32 v202, -v205, v201, v202
    v_fmac_f32 v203, v205, v200
    v_cvt_pk_bf16_f32 v247, v202, v203
    v_mul_f32 v206, v202, v198
    v_mul_f32 v207, v202, v199
    v_fma_f32 v206, -v203, v199, v206
    v_fmac_f32 v207, v203, v198
    v_cvt_pk_bf16_f32 v248, v206, v207
    v_mul_f32 v204, v202, v200
    v_mul_f32 v205, v202, v201
    v_fma_f32 v204, -v203, v201, v204
    v_fmac_f32 v205, v203, v200
    v_cvt_pk_bf16_f32 v249, v204, v205
    v_mul_f32 v206, v204, v198
    v_mul_f32 v207, v204, v199
    v_fma_f32 v206, -v205, v199, v206
    v_fmac_f32 v207, v205, v198
    v_cvt_pk_bf16_f32 v250, v206, v207
    s_branch L_td_45
L_tv_44:
    v_mul_f32 v196, v194, v198
    v_mul_f32 v197, v194, v199
    v_fma_f32 v196, -v195, v199, v196
    v_fmac_f32 v197, v195, v198
    v_cvt_pk_bf16_f32 v238, v208, v209
    v_cvt_pk_bf16_f32 v239, v196, v197
    v_mul_f32 v206, v208, v198
    v_mul_f32 v207, v208, v199
    v_fma_f32 v206, -v209, v199, v206
    v_fmac_f32 v207, v209, v198
    v_mul_f32 v194, v196, v198
    v_mul_f32 v195, v196, v199
    v_fma_f32 v194, -v197, v199, v194
    v_fmac_f32 v195, v197, v198
    v_cvt_pk_bf16_f32 v240, v206, v207
    v_cvt_pk_bf16_f32 v241, v194, v195
    v_mul_f32 v208, v206, v198
    v_mul_f32 v209, v206, v199
    v_fma_f32 v208, -v207, v199, v208
    v_fmac_f32 v209, v207, v198
    v_mul_f32 v196, v194, v198
    v_mul_f32 v197, v194, v199
    v_fma_f32 v196, -v195, v199, v196
    v_fmac_f32 v197, v195, v198
    v_cvt_pk_bf16_f32 v242, v208, v209
    v_cvt_pk_bf16_f32 v243, v196, v197
    v_mul_f32 v206, v208, v198
    v_mul_f32 v207, v208, v199
    v_fma_f32 v206, -v209, v199, v206
    v_fmac_f32 v207, v209, v198
    v_mul_f32 v194, v196, v198
    v_mul_f32 v195, v196, v199
    v_fma_f32 v194, -v197, v199, v194
    v_fmac_f32 v195, v197, v198
    v_cvt_pk_bf16_f32 v244, v206, v207
    v_cvt_pk_bf16_f32 v245, v194, v195
    v_mul_f32 v208, v206, v198
    v_mul_f32 v209, v206, v199
    v_fma_f32 v208, -v207, v199, v208
    v_fmac_f32 v209, v207, v198
    v_mul_f32 v196, v194, v198
    v_mul_f32 v197, v194, v199
    v_fma_f32 v196, -v195, v199, v196
    v_fmac_f32 v197, v195, v198
    v_cvt_pk_bf16_f32 v246, v208, v209
    v_cvt_pk_bf16_f32 v247, v196, v197
    v_mul_f32 v206, v208, v198
    v_mul_f32 v207, v208, v199
    v_fma_f32 v206, -v209, v199, v206
    v_fmac_f32 v207, v209, v198
    v_mul_f32 v194, v196, v198
    v_mul_f32 v195, v196, v199
    v_fma_f32 v194, -v197, v199, v194
    v_fmac_f32 v195, v197, v198
    v_cvt_pk_bf16_f32 v248, v206, v207
    v_cvt_pk_bf16_f32 v249, v194, v195
    v_mul_f32 v208, v206, v198
    v_mul_f32 v209, v206, v199
    v_fma_f32 v208, -v207, v199, v208
    v_fmac_f32 v209, v207, v198
    v_mul_f32 v196, v194, v198
    v_mul_f32 v197, v194, v199
    v_fma_f32 v196, -v195, v199, v196
    v_fmac_f32 v197, v195, v198
    v_cvt_pk_bf16_f32 v250, v208, v209
    v_cvt_pk_bf16_f32 v251, v196, v197
    v_mul_f32 v206, v208, v198
    v_mul_f32 v207, v208, v199
    v_fma_f32 v206, -v209, v199, v206
    v_fmac_f32 v207, v209, v198
    v_mul_f32 v194, v196, v198
    v_mul_f32 v195, v196, v199
    v_fma_f32 v194, -v197, v199, v194
    v_fmac_f32 v195, v197, v198
    v_cvt_pk_bf16_f32 v252, v206, v207
    v_cvt_pk_bf16_f32 v253, v194, v195
    v_mul_f32 v208, v206, v198
    v_mul_f32 v209, v206, v199
    v_fma_f32 v208, -v207, v199, v208
    v_fmac_f32 v209, v207, v198
    v_mul_f32 v196, v194, v198
    v_mul_f32 v197, v194, v199
    v_fma_f32 v196, -v195, v199, v196
    v_fmac_f32 v197, v195, v198
    v_cvt_pk_bf16_f32 v254, v208, v209
    v_cvt_pk_bf16_f32 v255, v196, v197
L_td_45:
    s_mul_i32 s64, s60, 7
    s_lshr_b32 s65, s64, 1
    s_mul_i32 s66, s76, 28
    s_add_u32 s65, s65, s66
    v_min_u32 v28, 3, v0
    v_add_u32 v28, s65, v28
    v_lshlrev_b32 v28, 7, v28
    v_add_u32 v28, 32768, v28
    s_mul_i32 s65, s76, 56
    s_add_u32 s64, s64, s65
    s_lshl_b32 s64, s64, 12
    s_add_u32 s78, s64, 12845056
    s_and_b32 s64, s75, 3
    s_lshl_b32 s64, s64, 2
    s_lshr_b32 s64, 0x4040, s64
    s_and_b32 s64, s64, 7
    s_lshl_b32 s9, s64, 12
    v_lshrrev_b32 v24, 4, v0
    v_and_b32 v25, 0xf0, v30
    v_lshl_add_u32 v12, v24, 16, v25
    v_lshrrev_b32 v24, 1, v0
    v_and_b32 v25, 1, v0
    s_lshl_b32 s64, s60, 18
    s_lshl_b32 s65, s58, 8
    s_add_u32 s64, s64, s65
    s_add_u32 s89, s64, 1048576
    v_mul_u32_u24 v25, 16704, v25
    v_lshl_add_u32 v24, v24, 4, v25
    s_lshl_b32 s64, s60, 9
    s_add_u32 s64, s64, 123936
    v_add_u32 v31, s64, v24
    s_cmp_ge_u32 s70, 28
    s_cbranch_scc1 L_not_46
    s_waitcnt vmcnt(1)
    v_xor_b32 v67, s63, v67
    s_waitcnt vmcnt(0)
    v_xor_b32 v71, s63, v71
    v_or_b32 v67, v67, v71
    v_cmp_ne_u32 s[100:101], 0, v67
    s_nop 0
    s_cmp_lg_u64 s[100:101], 0
    s_cbranch_scc1 L_slow_47
L_back_48:
    v_add_f32 v64, v64, v68
    v_add_f32 v65, v65, v69
    ds_write_b64 v10, v[64:65]
    v_and_b32 v11, 31, v0
    v_lshrrev_b32 v14, 5, v0
    v_lshlrev_b32 v14, 2, v14
    v_lshl_or_b32 v11, v11, 3, v14
    v_add_u32 v11, s95, v11
    s_waitcnt lgkmcnt(0)
    s_barrier
    s_and_b32 s64, s60, 3
    s_cmp_lg_u32 s64, 0
    s_cbranch_scc1 L_nocs_50
    ds_read_b32 v64, v11 offset:0
    ds_read_b32 v66, v11 offset:256
    ds_read_b32 v68, v11 offset:512
    ds_read_b32 v70, v11 offset:768
    ds_read_b32 v72, v11 offset:1024
    ds_read_b32 v74, v11 offset:1280
    ds_read_b32 v76, v11 offset:1536
    ds_read_b32 v78, v11 offset:1792
    s_lshl_b32 s64, s70, 1
    s_add_u32 s64, s64, s93
    s_lshl_b32 s64, s64, 9
    s_add_u32 s64, s64, 196608
    v_mov_b32 v65, s63
    s_waitcnt lgkmcnt(3)
    v_add_f32 v64, v64, v72
    s_waitcnt lgkmcnt(2)
    v_add_f32 v66, v66, v74
    s_waitcnt lgkmcnt(1)
    v_add_f32 v68, v68, v76
    s_waitcnt lgkmcnt(0)
    v_add_f32 v70, v70, v78
    v_add_f32 v64, v64, v68
    v_add_f32 v66, v66, v70
    v_add_f32 v64, v64, v66
    buffer_store_dwordx2 v[64:65], v9, s[52:55], s64 offen sc1
L_nocs_50:
L_not_46:
    s_mov_b32 s83, 20971520
    buffer_load_dword v22, v28, s[52:55], 0 offen sc1
    s_waitcnt vmcnt(0)
    v_cmp_ne_u32 s[100:101], s63, v22
    s_nop 0
    s_cmp_lg_u64 s[100:101], 0
    s_cbranch_scc1 L_slow_51
L_back_52:
    s_add_u32 s79, s78, s9
    buffer_load_dwordx4 v[144:147], v30, s[52:55], s79 offen offset:0 sc1
    buffer_load_dwordx4 v[148:151], v30, s[52:55], s79 offen offset:1024 sc1
    buffer_load_dwordx4 v[152:155], v30, s[52:55], s79 offen offset:2048 sc1
    buffer_load_dwordx4 v[156:159], v30, s[52:55], s79 offen offset:3072 sc1
    s_add_u32 s9, s9, 4096
    s_cmp_eq_u32 s9, 28672
    s_cmov_b32 s9, 0
    s_add_u32 s79, s78, s9
    buffer_load_dwordx4 v[160:163], v30, s[52:55], s79 offen offset:0 sc1
    buffer_load_dwordx4 v[164:167], v30, s[52:55], s79 offen offset:1024 sc1
    buffer_load_dwordx4 v[168:171], v30, s[52:55], s79 offen offset:2048 sc1
    buffer_load_dwordx4 v[172:175], v30, s[52:55], s79 offen offset:3072 sc1
    s_add_u32 s9, s9, 4096
    s_cmp_eq_u32 s9, 28672
    s_cmov_b32 s9, 0
    s_add_u32 s79, s78, s9
    buffer_load_dwordx4 v[176:179], v30, s[52:55], s79 offen offset:0 sc1
    buffer_load_dwordx4 v[180:183], v30, s[52:55], s79 offen offset:1024 sc1
    buffer_load_dwordx4 v[184:187], v30, s[52:55], s79 offen offset:2048 sc1
    buffer_load_dwordx4 v[188:191], v30, s[52:55], s79 offen offset:3072 sc1
    s_add_u32 s9, s9, 4096
    s_cmp_eq_u32 s9, 28672
    s_cmov_b32 s9, 0
    s_lshl_b32 s64, s60, 2
    v_add_u32 v28, s64, v0
    v_min_u32 v28, 31, v28
    v_mov_b32 v24, 31
    v_cmp_gt_u32 vcc, 5, v0
    s_nop 1
    v_cndmask_b32 v28, v24, v28, vcc
    v_lshlrev_b32 v28, 7, v28
    v_add_u32 v28, 102400, v28
    buffer_load_dword v22, v28, s[52:55], 0 offen sc1
    s_waitcnt vmcnt(0)
    v_cmp_ne_u32 s[100:101], s63, v22
    s_nop 0
    s_cmp_lg_u64 s[100:101], 0
    s_cbranch_scc1 L_slow_54
L_back_55:
    buffer_load_dwordx4 v[8:11], v12, s[52:55], s89 offen sc1
    s_add_u32 s95, s89, 65312
    s_mov_b32 exec_lo, 0xc000c000
    s_mov_b32 exec_hi, 0xc000c000
    buffer_load_dwordx2 v[26:27], v12, s[52:55], s95 offen sc1
    s_mov_b64 exec, -1
    s_barrier
    s_cmp_ge_u32 s60, 4
    s_cbranch_scc1 L_sv
    s_mov_b32 s64, 3230828928
    s_mov_b32 s65, 757340946
    s_cmp_lg_u32 s86, 0
    s_cmov_b32 s64, 151048905
    s_cmov_b32 s65, 1363689270
    s_cmp_lg_u32 s93, 0
    s_cselect_b32 s5, s65, s64
    s_cmp_lg_u32 s77, 0
    s_cselect_b32 s7, s65, s64
    s_bfe_u32 s4, s5, 0x80000
    s_bfe_u32 s5, s5, 0x80008
    s_bfe_u32 s6, s7, 0x80010
    s_bfe_u32 s7, s7, 0x80018
    s_lshr_b32 s66, s60, 1
    s_lshl_b32 s66, s66, 3
    s_lshr_b32 s64, s64, s66
    s_lshr_b32 s65, s65, s66
    s_and_b32 s64, s64, 0xff
    s_and_b32 s65, s65, 0xff
    s_lshl_b32 s80, s64, 9
    s_lshl_b32 s8, s65, 9
    v_and_b32 v24, 15, v0
    v_lshrrev_b32 v25, 4, v0
    v_mul_u32_u24 v220, 288, v24
    v_lshl_add_u32 v220, v25, 4, v220
    v_lshl_add_u32 v208, s4, 9, v220
    v_lshl_add_u32 v209, s5, 9, v220
    v_lshl_add_u32 v210, s6, 9, v220
    v_lshl_add_u32 v211, s7, 9, v220
    v_add_u32 v220, 1, v24
    v_and_b32 v221, 3, v220
    v_sub_u32 v220, v220, v221
    v_lshl_add_u32 v220, v25, 3, v220
    v_mul_u32_u24 v221, 4160, v221
    v_lshl_add_u32 v218, v220, 1, v221
    v_lshlrev_b32 v220, 5, v24
    v_lshlrev_b32 v221, 4, v25
    v_sub_u32 v219, v221, v220
    v_lshl_add_u32 v24, s77, 4, v24
    s_mul_i32 s64, s86, 4608
    s_add_u32 s65, s64, 118784
    v_lshl_add_u32 v212, v13, 2, s65
    v_mov_b32 v220, 0
    v_mov_b32 v221, 0
    v_mov_b32 v222, 0
    v_mov_b32 v223, 0
    ds_write_b128 v212, v[220:223]
    v_lshrrev_b32 v212, 1, v25
    v_lshlrev_b32 v212, 9, v212
    v_lshl_add_u32 v212, v24, 4, v212
    v_and_b32 v25, 1, v25
    v_lshl_add_u32 v212, v25, 3, v212
    s_add_u32 s65, s64, 118776
    v_sub_u32 v212, s65, v212
    s_mov_b32 m0, s80
    s_nop 0
    ds_write_addtid_b32 v224 offset:0
    ds_write_addtid_b32 v225 offset:288
    ds_write_addtid_b32 v226 offset:576
    ds_write_addtid_b32 v227 offset:864
    ds_write_addtid_b32 v228 offset:1152
    ds_write_addtid_b32 v229 offset:1440
    ds_write_addtid_b32 v230 offset:1728
    ds_write_addtid_b32 v231 offset:2016
    ds_write_addtid_b32 v232 offset:2304
    ds_write_addtid_b32 v232 offset:2592
    ds_write_addtid_b32 v233 offset:2880
    ds_write_addtid_b32 v234 offset:3168
    ds_write_addtid_b32 v234 offset:3456
    ds_write_addtid_b32 v234 offset:3744
    ds_write_addtid_b32 v235 offset:4032
    ds_write_addtid_b32 v236 offset:4320
    s_mov_b32 m0, s8
    s_nop 0
    ds_write_addtid_b32 v237 offset:0
    ds_write_addtid_b32 v238 offset:288
    ds_write_addtid_b32 v239 offset:576
    ds_write_addtid_b32 v239 offset:864
    ds_write_addtid_b32 v240 offset:1152
    ds_write_addtid_b32 v241 offset:1440
    ds_write_addtid_b32 v242 offset:1728
    ds_write_addtid_b32 v242 offset:2016
    ds_write_addtid_b32 v243 offset:2304
    ds_write_addtid_b32 v244 offset:2592
    ds_write_addtid_b32 v245 offset:2880
    ds_write_addtid_b32 v246 offset:3168
    ds_write_addtid_b32 v247 offset:3456
    ds_write_addtid_b32 v248 offset:3744
    ds_write_addtid_b32 v249 offset:4032
    ds_write_addtid_b32 v250 offset:4320
    s_waitcnt vmcnt(1)
    ds_write_b128 v31, v[8:11]
    s_waitcnt vmcnt(0)
    v_mov_b32_dpp v26, v8 row_shl:2 row_mask:0xf bank_mask:0xf
    v_mov_b32_dpp v27, v9 row_shl:2 row_mask:0xf bank_mask:0xf
    v_alignbit_b32 v220, v9, v8, 16
    v_alignbit_b32 v221, v10, v9, 16
    v_alignbit_b32 v222, v11, v10, 16
    v_alignbit_b32 v223, v26, v11, 16
    ds_write_b128 v31, v[220:223] offset:4160
    v_mov_b32 v220, v9
    v_mov_b32 v221, v10
    v_mov_b32 v222, v11
    v_mov_b32 v223, v26
    ds_write_b128 v31, v[220:223] offset:8320
    v_alignbit_b32 v220, v10, v9, 16
    v_alignbit_b32 v221, v11, v10, 16
    v_alignbit_b32 v222, v26, v11, 16
    v_alignbit_b32 v223, v27, v26, 16
    ds_write_b128 v31, v[220:223] offset:12480
    s_cmp_lg_u32 s60, 0
    s_cbranch_scc1 L_w0_57
    v_lshlrev_b32 v220, 16, v8
    v_alignbit_b32 v221, v9, v8, 16
    s_mov_b64 exec, 3
    ds_write_b32 v31, v220 offset:4156
    ds_write_b32 v31, v8 offset:8316
    ds_write_b32 v31, v220 offset:12472
    ds_write_b32 v31, v221 offset:12476
    s_mov_b64 exec, -1
L_w0_57:
    s_waitcnt lgkmcnt(0)
    s_barrier
    ds_read_b128 v[224:227], v208 offset:0
    ds_read_b128 v[228:231], v210 offset:0
    ds_read_b128 v[232:235], v208 offset:64
    ds_read_b128 v[236:239], v210 offset:64
    ds_read_b128 v[240:243], v208 offset:128
    ds_read_b128 v[244:247], v210 offset:128
    ds_read_b128 v[248:251], v208 offset:192
    ds_read_b128 v[252:255], v210 offset:192
    s_lshl_b32 s64, s93, 8
    s_mul_i32 s65, s86, 16704
    s_add_u32 s65, s65, s64
    s_add_u32 s65, s65, 123904
    v_add_u32 v1, s65, v218
    s_mul_i32 s65, s86, 4608
    s_add_u32 s65, s65, s64
    s_add_u32 s65, s65, 115168
    v_add_u32 v2, s65, v219
    s_waitcnt lgkmcnt(6)
    v_mfma_f32_16x16x32_bf16 v[112:115], v[224:227], v[228:231], 0
    s_waitcnt lgkmcnt(4)
    v_mfma_f32_16x16x32_bf16 v[112:115], v[232:235], v[236:239], v[112:115]
    s_waitcnt lgkmcnt(2)
    v_mfma_f32_16x16x32_bf16 v[112:115], v[240:243], v[244:247], v[112:115]
    s_waitcnt lgkmcnt(0)
    v_mfma_f32_16x16x32_bf16 v[112:115], v[248:251], v[252:255], v[112:115]
    ds_read_b128 v[224:227], v209 offset:0
    ds_read_b128 v[228:231], v211 offset:0
    ds_read_b128 v[232:235], v209 offset:64
    ds_read_b128 v[236:239], v211 offset:64
    ds_read_b128 v[240:243], v209 offset:128
    ds_read_b128 v[244:247], v211 offset:128
    ds_read_b128 v[248:251], v209 offset:192
    ds_read_b128 v[252:255], v211 offset:192
    s_waitcnt lgkmcnt(6)
    v_mfma_f32_16x16x32_bf16 v[112:115], v[224:227], v[228:231], v[112:115]
    s_waitcnt lgkmcnt(4)
    v_mfma_f32_16x16x32_bf16 v[112:115], v[232:235], v[236:239], v[112:115]
    s_waitcnt lgkmcnt(2)
    v_mfma_f32_16x16x32_bf16 v[112:115], v[240:243], v[244:247], v[112:115]
    s_waitcnt lgkmcnt(0)
    v_mfma_f32_16x16x32_bf16 v[112:115], v[248:251], v[252:255], v[112:115]
    s_nop 7
    v_cvt_pk_bf16_f32 v116, v115, v114
    v_cvt_pk_bf16_f32 v117, v113, v112
    ds_write_b64 v212, v[116:117]
    s_add_u32 s79, s78, s9
    buffer_load_dwordx4 v[192:195], v30, s[52:55], s79 offen offset:0 sc1
    buffer_load_dwordx4 v[196:199], v30, s[52:55], s79 offen offset:1024 sc1
    buffer_load_dwordx4 v[200:203], v30, s[52:55], s79 offen offset:2048 sc1
    buffer_load_dwordx4 v[204:207], v30, s[52:55], s79 offen offset:3072 sc1
    s_add_u32 s9, s9, 4096
    s_cmp_eq_u32 s9, 28672
    s_cmov_b32 s9, 0
    s_branch L_post
L_sv:
    s_mov_b32 s64, 3230828928
    s_mov_b32 s65, 757340946
    s_cmp_lg_u32 s86, 0
    s_cmov_b32 s64, 151048905
    s_cmov_b32 s65, 1363689270
    s_cmp_lg_u32 s93, 0
    s_cselect_b32 s5, s65, s64
    s_cmp_lg_u32 s77, 0
    s_cselect_b32 s7, s65, s64
    s_bfe_u32 s4, s5, 0x80000
    s_bfe_u32 s5, s5, 0x80008
    s_bfe_u32 s6, s7, 0x80010
    s_bfe_u32 s7, s7, 0x80018
    s_lshr_b32 s66, s60, 1
    s_lshl_b32 s66, s66, 3
    s_lshr_b32 s64, s64, s66
    s_lshr_b32 s65, s65, s66
    s_and_b32 s64, s64, 0xff
    s_and_b32 s65, s65, 0xff
    s_lshl_b32 s80, s64, 9
    s_lshl_b32 s8, s65, 9
    v_and_b32 v24, 15, v0
    v_lshrrev_b32 v25, 4, v0
    v_mul_u32_u24 v220, 288, v24
    v_lshl_add_u32 v220, v25, 4, v220
    v_lshl_add_u32 v208, s4, 9, v220
    v_lshl_add_u32 v209, s5, 9, v220
    v_lshl_add_u32 v210, s6, 9, v220
    v_lshl_add_u32 v211, s7, 9, v220
    v_add_u32 v220, 1, v24
    v_and_b32 v221, 3, v220
    v_sub_u32 v220, v220, v221
    v_lshl_add_u32 v220, v25, 3, v220
    v_mul_u32_u24 v221, 4160, v221
    v_lshl_add_u32 v218, v220, 1, v221
    v_lshlrev_b32 v220, 5, v24
    v_lshlrev_b32 v221, 4, v25
    v_sub_u32 v219, v221, v220
    v_lshl_add_u32 v24, s77, 4, v24
    s_mul_i32 s64, s86, 4608
    s_add_u32 s65, s64, 118784
    v_lshl_add_u32 v212, v13, 2, s65
    v_mov_b32 v220, 0
    v_mov_b32 v221, 0
    v_mov_b32 v222, 0
    v_mov_b32 v223, 0
    ds_write_b128 v212, v[220:223]
    v_cmp_gt_u32 s[70:71], 32, v0
    v_add_u32 v212, 2, v25
    v_lshlrev_b32 v25, 1, v25
    v_cndmask_b32 v212, v25, v212, s[70:71]
    v_lshlrev_b32 v212, 9, v212
    v_lshl_add_u32 v212, v24, 4, v212
    s_add_u32 s65, s64, 118256
    v_sub_u32 v212, s65, v212
    v_mov_b32 v213, 0x3020302
    v_mov_b32 v24, 0x5040504
    v_mov_b32 v25, 0x1000302
    v_mov_b32 v214, 0x1000100
    v_cndmask_b32 v215, v213, v24, s[70:71]
    v_cndmask_b32 v216, v214, v25, s[70:71]
    v_and_b32 v24, 33, v0
    v_cmp_eq_u32 s[70:71], 32, v24
    s_nop 1
    v_cndmask_b32 v217, v213, v25, s[70:71]
    s_mov_b32 m0, s80
    s_nop 0
    ds_write_addtid_b32 v224 offset:0
    ds_write_addtid_b32 v226 offset:288
    ds_write_addtid_b32 v228 offset:576
    ds_write_addtid_b32 v230 offset:864
    ds_write_addtid_b32 v232 offset:1152
    ds_write_addtid_b32 v234 offset:1440
    ds_write_addtid_b32 v236 offset:1728
    ds_write_addtid_b32 v238 offset:2016
    ds_write_addtid_b32 v240 offset:2304
    ds_write_addtid_b32 v242 offset:2592
    ds_write_addtid_b32 v244 offset:2880
    ds_write_addtid_b32 v246 offset:3168
    ds_write_addtid_b32 v248 offset:3456
    ds_write_addtid_b32 v250 offset:3744
    ds_write_addtid_b32 v252 offset:4032
    ds_write_addtid_b32 v254 offset:4320
    s_mov_b32 m0, s8
    s_nop 0
    ds_write_addtid_b32 v225 offset:0
    ds_write_addtid_b32 v227 offset:288
    ds_write_addtid_b32 v229 offset:576
    ds_write_addtid_b32 v231 offset:864
    ds_write_addtid_b32 v233 offset:1152
    ds_write_addtid_b32 v235 offset:1440
    ds_write_addtid_b32 v237 offset:1728
    ds_write_addtid_b32 v239 offset:2016
    ds_write_addtid_b32 v241 offset:2304
    ds_write_addtid_b32 v243 offset:2592
    ds_write_addtid_b32 v245 offset:2880
    ds_write_addtid_b32 v247 offset:3168
    ds_write_addtid_b32 v249 offset:3456
    ds_write_addtid_b32 v251 offset:3744
    ds_write_addtid_b32 v253 offset:4032
    ds_write_addtid_b32 v255 offset:4320
    s_waitcnt vmcnt(1)
    ds_write_b128 v31, v[8:11]
    s_waitcnt vmcnt(0)
    v_mov_b32_dpp v26, v8 row_shl:2 row_mask:0xf bank_mask:0xf
    v_mov_b32_dpp v27, v9 row_shl:2 row_mask:0xf bank_mask:0xf
    v_alignbit_b32 v220, v9, v8, 16
    v_alignbit_b32 v221, v10, v9, 16
    v_alignbit_b32 v222, v11, v10, 16
    v_alignbit_b32 v223, v26, v11, 16
    ds_write_b128 v31, v[220:223] offset:4160
    v_mov_b32 v220, v9
    v_mov_b32 v221, v10
    v_mov_b32 v222, v11
    v_mov_b32 v223, v26
    ds_write_b128 v31, v[220:223] offset:8320
    v_alignbit_b32 v220, v10, v9, 16
    v_alignbit_b32 v221, v11, v10, 16
    v_alignbit_b32 v222, v26, v11, 16
    v_alignbit_b32 v223, v27, v26, 16
    ds_write_b128 v31, v[220:223] offset:12480
    s_waitcnt lgkmcnt(0)
    s_barrier
    ds_read_b128 v[224:227], v208 offset:0
    ds_read_b128 v[228:231], v210 offset:0
    ds_read_b128 v[232:235], v208 offset:64
    ds_read_b128 v[236:239], v210 offset:64
    ds_read_b128 v[240:243], v208 offset:128
    ds_read_b128 v[244:247], v210 offset:128
    ds_read_b128 v[248:251], v208 offset:192
    ds_read_b128 v[252:255], v210 offset:192
    s_lshl_b32 s64, s93, 8
    s_mul_i32 s65, s86, 16704
    s_add_u32 s65, s65, s64
    s_add_u32 s65, s65, 123904
    v_add_u32 v1, s65, v218
    s_mul_i32 s65, s86, 4608
    s_add_u32 s65, s65, s64
    s_add_u32 s65, s65, 115168
    v_add_u32 v2, s65, v219
    s_waitcnt lgkmcnt(6)
    v_mfma_f32_16x16x32_bf16 v[112:115], v[224:227], v[228:231], 0
    s_waitcnt lgkmcnt(4)
    v_mfma_f32_16x16x32_bf16 v[112:115], v[232:235], v[236:239], v[112:115]
    s_waitcnt lgkmcnt(2)
    v_mfma_f32_16x16x32_bf16 v[112:115], v[240:243], v[244:247], v[112:115]
    s_waitcnt lgkmcnt(0)
    v_mfma_f32_16x16x32_bf16 v[112:115], v[248:251], v[252:255], v[112:115]
    ds_read_b128 v[224:227], v209 offset:0
    ds_read_b128 v[228:231], v211 offset:0
    ds_read_b128 v[232:235], v209 offset:64
    ds_read_b128 v[236:239], v211 offset:64
    ds_read_b128 v[240:243], v209 offset:128
    ds_read_b128 v[244:247], v211 offset:128
    ds_read_b128 v[248:251], v209 offset:192
    ds_read_b128 v[252:255], v211 offset:192
    s_waitcnt lgkmcnt(6)
    v_mfma_f32_16x16x32_bf16 v[112:115], v[224:227], v[228:231], v[112:115]
    s_waitcnt lgkmcnt(4)
    v_mfma_f32_16x16x32_bf16 v[112:115], v[232:235], v[236:239], v[112:115]
    s_waitcnt lgkmcnt(2)
    v_mfma_f32_16x16x32_bf16 v[112:115], v[240:243], v[244:247], v[112:115]
    s_waitcnt lgkmcnt(0)
    v_mfma_f32_16x16x32_bf16 v[112:115], v[248:251], v[252:255], v[112:115]
    s_nop 7
    v_cvt_pk_bf16_f32 v124, v112, v113
    v_cvt_pk_bf16_f32 v125, v114, v115
    v_perm_b32 v116, v125, v124, v215
    v_perm_b32 v117, v125, v124, v217
    v_perm_b32 v118, v125, v124, v216
    v_perm_b32 v119, v125, v124, v214
    ds_write_b128 v212, v[116:119] offset:512
    v_perm_b32 v120, v125, v125, v213
    v_perm_b32 v121, v125, v125, v217
    v_perm_b32 v122, v125, v125, v214
    v_perm_b32 v123, v125, v125, v214
    s_mov_b32 exec_lo, 0
    ds_write_b128 v212, v[120:123]
    s_mov_b64 exec, -1
    s_add_u32 s79, s78, s9
    buffer_load_dwordx4 v[192:195], v30, s[52:55], s79 offen offset:0 sc1
    buffer_load_dwordx4 v[196:199], v30, s[52:55], s79 offen offset:1024 sc1
    buffer_load_dwordx4 v[200:203], v30, s[52:55], s79 offen offset:2048 sc1
    buffer_load_dwordx4 v[204:207], v30, s[52:55], s79 offen offset:3072 sc1
    s_add_u32 s9, s9, 4096
    s_cmp_eq_u32 s9, 28672
    s_cmov_b32 s9, 0
    s_branch L_post
L_slow_3:
    s_mov_b32 s69, 0
L_spin_5:
    buffer_load_dword v22, v28, s[52:55], 0 offen sc1
    s_add_u32 s69, s69, 1
    s_waitcnt vmcnt(0)
    s_cmp_gt_u32 s69, 400000
    s_cbranch_scc1 L_back_4
    v_cmp_ne_u32 s[100:101], s63, v22
    s_nop 0
    s_cmp_lg_u64 s[100:101], 0
    s_cbranch_scc1 L_spin_5
    s_branch L_back_4
L_slow_6:
    s_mov_b32 s69, 0
L_spin_8:
    buffer_load_dword v22, v28, s[52:55], 0 offen sc1
    s_add_u32 s69, s69, 1
    s_waitcnt vmcnt(0)
    s_cmp_gt_u32 s69, 400000
    s_cbranch_scc1 L_back_7
    v_cmp_ne_u32 s[100:101], s63, v22
    s_nop 0
    s_cmp_lg_u64 s[100:101], 0
    s_cbranch_scc1 L_spin_8
    s_branch L_back_7
L_slow_9:
    s_mov_b32 s69, 0
L_spin_11:
    buffer_load_dwordx2 v[20:21], v14, s[52:55], s90 offen sc1
    s_add_u32 s69, s69, 1
    s_waitcnt vmcnt(0)
    s_cmp_gt_u32 s69, 400000
    s_cbranch_scc1 L_back_10
    v_cmp_ne_u32 s[100:101], s63, v21
    s_nop 0
    s_cmp_lg_u64 s[100:101], 0
    s_cbranch_scc1 L_spin_11
    s_branch L_back_10
L_slow_17:
    s_mov_b32 s69, 0
L_spin_19:
    buffer_load_dword v22, v28, s[52:55], 0 offen sc1
    s_add_u32 s69, s69, 1
    s_waitcnt vmcnt(0)
    s_cmp_gt_u32 s69, 400000
    s_cbranch_scc1 L_back_18
    v_cmp_ne_u32 s[100:101], s63, v22
    s_nop 0
    s_cmp_lg_u64 s[100:101], 0
    s_cbranch_scc1 L_spin_19
    s_branch L_back_18
L_slow_20:
    s_mov_b32 s69, 0
L_spin_22:
    buffer_load_dword v22, v28, s[52:55], 0 offen sc1
    s_add_u32 s69, s69, 1
    s_waitcnt vmcnt(0)
    s_cmp_gt_u32 s69, 400000
    s_cbranch_scc1 L_back_21
    v_cmp_ne_u32 s[100:101], s63, v22
    s_nop 0
    s_cmp_lg_u64 s[100:101], 0
    s_cbranch_scc1 L_spin_22
    s_branch L_back_21
L_slow_23:
    s_mov_b32 s69, 0
L_spin_25:
    buffer_load_dwordx2 v[20:21], v14, s[52:55], s90 offen sc1
    s_add_u32 s69, s69, 1
    s_waitcnt vmcnt(0)
    s_cmp_gt_u32 s69, 400000
    s_cbranch_scc1 L_back_24
    v_cmp_ne_u32 s[100:101], s63, v21
    s_nop 0
    s_cmp_lg_u64 s[100:101], 0
    s_cbranch_scc1 L_spin_25
    s_branch L_back_24
L_slow_30:
    s_mov_b32 s69, 0
L_spin_32:
    buffer_load_dword v22, v7, s[52:55], 0 offen offset:12 sc1
    s_add_u32 s69, s69, 1
    s_waitcnt vmcnt(0)
    s_cmp_gt_u32 s69, 400000
    s_cbranch_scc1 L_back_31
    v_cmp_ne_u32 s[100:101], s63, v22
    s_nop 0
    s_cmp_lg_u64 s[100:101], 0
    s_cbranch_scc1 L_spin_32
    s_branch L_back_31
L_slow_33:
    s_mov_b32 s69, 0
L_spin_35:
    buffer_load_dword v22, v7, s[52:55], 0 offen offset:12 sc1
    s_add_u32 s69, s69, 1
    s_waitcnt vmcnt(0)
    s_cmp_gt_u32 s69, 400000
    s_cbranch_scc1 L_back_34
    v_cmp_ne_u32 s[100:101], s63, v22
    s_nop 0
    s_cmp_lg_u64 s[100:101], 0
    s_cbranch_scc1 L_spin_35
    s_branch L_back_34
L_slow_37:
    s_mov_b32 s69, 0
L_spin_39:
    buffer_load_dwordx4 v[16:19], v8, s[52:55], s89 offen sc1
    buffer_load_dwordx4 v[4:7], v8, s[52:55], s90 offen sc1
    s_add_u32 s69, s69, 1
    s_waitcnt vmcnt(0)
    s_cmp_gt_u32 s69, 400000
    s_cbranch_scc1 L_back_38
    v_xor_b32 v18, s63, v18
    v_xor_b32 v6, s63, v6
    v_or_b32 v18, v18, v6
    v_cmp_ne_u32 s[100:101], 0, v18
    s_nop 0
    s_cmp_lg_u64 s[100:101], 0
    s_cbranch_scc1 L_spin_39
    s_branch L_back_38
L_slow_47:
    s_mov_b32 s69, 0
L_spin_49:
    buffer_load_dwordx4 v[64:67], v30, s[52:55], s90 offen offset:0 sc1
    buffer_load_dwordx4 v[68:71], v30, s[52:55], s90 offen offset:1024 sc1
    s_add_u32 s69, s69, 1
    s_waitcnt vmcnt(0)
    s_cmp_gt_u32 s69, 400000
    s_cbranch_scc1 L_back_48
    v_xor_b32 v67, s63, v67
    v_xor_b32 v71, s63, v71
    v_or_b32 v67, v67, v71
    v_cmp_ne_u32 s[100:101], 0, v67
    s_nop 0
    s_cmp_lg_u64 s[100:101], 0
    s_cbranch_scc1 L_spin_49
    s_branch L_back_48
L_slow_51:
    s_mov_b32 s69, 0
L_spin_53:
    buffer_load_dword v22, v28, s[52:55], 0 offen sc1
    s_add_u32 s69, s69, 1
    s_waitcnt vmcnt(0)
    s_cmp_gt_u32 s69, 400000
    s_cbranch_scc1 L_back_52
    v_cmp_ne_u32 s[100:101], s63, v22
    s_nop 0
    s_cmp_lg_u64 s[100:101], 0
    s_cbranch_scc1 L_spin_53
    s_branch L_back_52
L_slow_54:
    s_mov_b32 s69, 0
L_spin_56:
    buffer_load_dword v22, v28, s[52:55], 0 offen sc1
    s_add_u32 s69, s69, 1
    s_waitcnt vmcnt(0)
    s_cmp_gt_u32 s69, 400000
    s_cbranch_scc1 L_back_55
    v_cmp_ne_u32 s[100:101], s63, v22
    s_nop 0
    s_cmp_lg_u64 s[100:101], 0
    s_cbranch_scc1 L_spin_56
    s_branch L_back_55
L_end:
.section .rodata,"a"
.p2align 6
.amdhsa_kernel parallel_sum__ssm_conv_s4__glu_gated_reglu__prompt_kernel
  .amdhsa_next_free_vgpr 256
  .amdhsa_next_free_sgpr 102
  .amdhsa_accum_offset 256
  .amdhsa_group_segment_fixed_size 0
  .amdhsa_kernarg_size 128
  .amdhsa_user_sgpr_count 2
  .amdhsa_user_sgpr_kernarg_segment_ptr 1
  .amdhsa_system_sgpr_workgroup_id_x 1
.end_amdhsa_kernel
```
